```python
import torch

def _softmax(x, axis=-1):
    return torch.softmax(x, dim=axis)
def _gelu(x):
    return torch.nn.functional.gelu(x, approximate="tanh")
def _silu(x):
    return torch.nn.functional.silu(x)
def _sigmoid(x):
    return torch.sigmoid(x)
def _layernorm(x, axis=-1, eps=1e-5):
    m = x.mean(dim=axis, keepdim=True)
    v = x.var(dim=axis, keepdim=True, unbiased=False)
    return (x - m) / torch.sqrt(v + eps)
def _scatter_add(tgt, idx, src, axis=0):
    return tgt.clone().index_add_(axis, idx, src)
def _segment_sum(src, seg, n):
    out = torch.zeros((n,) + src.shape[1:], dtype=src.dtype)
    return out.index_add_(0, seg, src)
def _pad(x, pw):
    flat = tuple(v for pair in reversed(pw) for v in pair)
    return torch.nn.functional.pad(x, flat)

kernel_name = 'standalone__groupnorm__sampling'

def setup_inputs():

    _w = (lambda a: (lambda t: t.to(torch.bfloat16) if t.is_floating_point() else t)(torch.as_tensor(a)))
    B = 32
    G = 32
    cpg = max(1, 1024 // G)
    C = G * cpg
    H, W = 32, 32
    return {
        "x": _w(abs((lambda *s: torch.randn(*s, dtype=torch.bfloat16) * 0.05)(B, C, H, W))),
        "g": _w((lambda *s: torch.randn(*s, dtype=torch.bfloat16) * 0.05)(C) + 1.0),
        "b": _w((lambda *s: torch.randn(*s, dtype=torch.bfloat16) * 0.4)(C)),
    }

def reference(x, g, b):
    G = 32
    B, C, H, W = x.shape[0], x.shape[1], x.shape[2], x.shape[3]
    xr = x.reshape(B, G, C // G, H, W)
    mu = xr.mean(axis=(2, 3, 4), keepdims=True)
    var = ((xr - mu) ** 2).mean(axis=(2, 3, 4), keepdims=True)
    xn = (xr - mu) / torch.sqrt(var + 1e-5)
    xn = xn.reshape(B, C, H, W)
    return xn * g[None, :, None, None] + b[None, :, None, None]
```

```asm
; @launch grid=(256,1,1) block=(512,1,1) lds=1088
.amdgcn_target "amdgcn-amd-amdhsa--gfx950"
.text
.globl standalone__groupnorm__sampling_kernel
.p2align 8
.type standalone__groupnorm__sampling_kernel,@function
standalone__groupnorm__sampling_kernel:
    s_load_dwordx8 s[8:15], s[0:1], 0
    s_load_dwordx4 s[16:19], s[0:1], 32
    v_lshrrev_b32 v3, 6, v0
    v_and_b32 v12, 63, v0
    v_lshlrev_b32 v12, 4, v12
    v_readfirstlane_b32 s3, v3
    s_cmpk_ge_u32 s2, 0x100
    s_cbranch_scc1 L_end
    s_bfe_u32 s39, s2, 0x30005
    s_xor_b32 s39, s39, s2
    s_lshl3_add_u32 s44, s39, s3
    s_lshl3_add_u32 s5, s2, s3
    s_lshl1_add_u32 s44, s44, 1
    s_lshl_b32 s44, s44, 12
    v_add_u32 v1, s44, v12
    s_andn2_b32 s5, s5, 0x3f9
    s_cbranch_scc0 L_odd
L_go:
    s_waitcnt lgkmcnt(0)
L_go2:
    global_load_dwordx4 v[44:47], v1, s[8:9] offset:-4096 nt
    global_load_dwordx4 v[48:51], v1, s[8:9] offset:-3072 nt
    global_load_dwordx4 v[52:55], v1, s[8:9] offset:-2048 nt
    global_load_dwordx4 v[56:59], v1, s[8:9] offset:-1024 nt
    global_load_dwordx4 v[60:63], v1, s[8:9] offset:0 nt
    global_load_dwordx4 v[64:67], v1, s[8:9] offset:1024 nt
    global_load_dwordx4 v[68:71], v1, s[8:9] offset:2048 nt
    global_load_dwordx4 v[72:75], v1, s[8:9] offset:3072 nt
    v_add_u32 v2, 0x1000000, v1
    s_barrier
    global_load_dwordx4 v[76:79], v2, s[8:9] offset:-4096 nt
    global_load_dwordx4 v[80:83], v2, s[8:9] offset:-3072 nt
    global_load_dwordx4 v[84:87], v2, s[8:9] offset:-2048 nt
    global_load_dwordx4 v[88:91], v2, s[8:9] offset:-1024 nt
    global_load_dwordx4 v[92:95], v2, s[8:9] offset:0 nt
    global_load_dwordx4 v[96:99], v2, s[8:9] offset:1024 nt
    global_load_dwordx4 v[100:103], v2, s[8:9] offset:2048 nt
    global_load_dwordx4 v[104:107], v2, s[8:9] offset:3072 nt
    s_and_b32 s36, s2, 3
    s_lshl_b32 s36, s36, 6
    s_bfe_u32 s5, s44, 0x8000d
    s_lshl_b32 s5, s5, 3
    s_load_dwordx2 s[20:21], s[10:11], s5
    s_load_dwordx2 s[22:23], s[12:13], s5
    s_mov_b32 s30, 0x3f803f80
    s_mov_b32 s31, 0xffff0000
    v_and_b32 v8, 0x30, v0
    s_lshr_b32 s6, s3, 1
    s_and_b32 s7, s3, 1
    s_lshl3_add_u32 s5, s6, s7
    s_lshl_b32 s5, s5, 3
    v_add_u32 v14, s5, v8
    v_and_b32 v3, 15, v0
    v_lshlrev_b32 v3, 4, v3
    s_mov_b64 vcc, 0xaa
    s_waitcnt lgkmcnt(0)
    s_lshl_b32 s40, s20, 16
    s_lshl_b32 s32, s22, 16
    s_and_b32 s41, s20, s31
    s_and_b32 s33, s22, s31
    s_lshl_b32 s42, s21, 16
    s_lshl_b32 s34, s23, 16
    s_and_b32 s43, s21, s31
    s_and_b32 s35, s23, s31
    v_mov_b32 v4, 0
    v_mov_b32 v5, 0
    s_waitcnt vmcnt(15)
    v_dot2c_f32_bf16 v4, s30, v44
    v_dot2c_f32_bf16 v5, v44, v44
    v_dot2c_f32_bf16 v4, s30, v45
    v_dot2c_f32_bf16 v5, v45, v45
    v_dot2c_f32_bf16 v4, s30, v46
    v_dot2c_f32_bf16 v5, v46, v46
    v_dot2c_f32_bf16 v4, s30, v47
    v_dot2c_f32_bf16 v5, v47, v47
    s_waitcnt vmcnt(14)
    v_dot2c_f32_bf16 v4, s30, v48
    v_dot2c_f32_bf16 v5, v48, v48
    v_dot2c_f32_bf16 v4, s30, v49
    v_dot2c_f32_bf16 v5, v49, v49
    v_dot2c_f32_bf16 v4, s30, v50
    v_dot2c_f32_bf16 v5, v50, v50
    v_dot2c_f32_bf16 v4, s30, v51
    v_dot2c_f32_bf16 v5, v51, v51
    s_waitcnt vmcnt(13)
    v_dot2c_f32_bf16 v4, s30, v52
    v_dot2c_f32_bf16 v5, v52, v52
    v_dot2c_f32_bf16 v4, s30, v53
    v_dot2c_f32_bf16 v5, v53, v53
    v_dot2c_f32_bf16 v4, s30, v54
    v_dot2c_f32_bf16 v5, v54, v54
    v_dot2c_f32_bf16 v4, s30, v55
    v_dot2c_f32_bf16 v5, v55, v55
    s_waitcnt vmcnt(12)
    v_dot2c_f32_bf16 v4, s30, v56
    v_dot2c_f32_bf16 v5, v56, v56
    v_dot2c_f32_bf16 v4, s30, v57
    v_dot2c_f32_bf16 v5, v57, v57
    v_dot2c_f32_bf16 v4, s30, v58
    v_dot2c_f32_bf16 v5, v58, v58
    v_dot2c_f32_bf16 v4, s30, v59
    v_dot2c_f32_bf16 v5, v59, v59
    s_waitcnt vmcnt(11)
    v_dot2c_f32_bf16 v4, s30, v60
    v_dot2c_f32_bf16 v5, v60, v60
    v_dot2c_f32_bf16 v4, s30, v61
    v_dot2c_f32_bf16 v5, v61, v61
    v_dot2c_f32_bf16 v4, s30, v62
    v_dot2c_f32_bf16 v5, v62, v62
    v_dot2c_f32_bf16 v4, s30, v63
    v_dot2c_f32_bf16 v5, v63, v63
    s_waitcnt vmcnt(10)
    v_dot2c_f32_bf16 v4, s30, v64
    v_dot2c_f32_bf16 v5, v64, v64
    v_dot2c_f32_bf16 v4, s30, v65
    v_dot2c_f32_bf16 v5, v65, v65
    v_dot2c_f32_bf16 v4, s30, v66
    v_dot2c_f32_bf16 v5, v66, v66
    v_dot2c_f32_bf16 v4, s30, v67
    v_dot2c_f32_bf16 v5, v67, v67
    s_waitcnt vmcnt(9)
    v_dot2c_f32_bf16 v4, s30, v68
    v_dot2c_f32_bf16 v5, v68, v68
    v_dot2c_f32_bf16 v4, s30, v69
    v_dot2c_f32_bf16 v5, v69, v69
    v_dot2c_f32_bf16 v4, s30, v70
    v_dot2c_f32_bf16 v5, v70, v70
    v_dot2c_f32_bf16 v4, s30, v71
    v_dot2c_f32_bf16 v5, v71, v71
    s_waitcnt vmcnt(8)
    v_dot2c_f32_bf16 v4, s30, v72
    v_dot2c_f32_bf16 v5, v72, v72
    v_dot2c_f32_bf16 v4, s30, v73
    v_dot2c_f32_bf16 v5, v73, v73
    v_dot2c_f32_bf16 v4, s30, v74
    v_dot2c_f32_bf16 v5, v74, v74
    v_dot2c_f32_bf16 v4, s30, v75
    v_dot2c_f32_bf16 v5, v75, v75
    s_nop 1
    v_mul_f32 v10, 0xbc800000, v4
    v_add_f32_dpp v8, v4, v4 quad_perm:[1,0,3,2] row_mask:0xf bank_mask:0xf
    v_fmac_f32 v5, v10, v4
    s_nop 0
    v_add_f32_dpp v8, v8, v8 quad_perm:[2,3,0,1] row_mask:0xf bank_mask:0xf
    s_nop 1
    v_add_f32_dpp v8, v8, v8 row_half_mirror row_mask:0xf bank_mask:0xf
    s_nop 1
    v_add_f32_dpp v8, v8, v8 row_mirror row_mask:0xf bank_mask:0xf
    v_fmac_f32 v4, 0xbd800000, v8
    v_mul_f32 v10, 0x3c800000, v4
    v_fmac_f32 v5, v10, v4
    v_mov_b32 v4, v8
    s_nop 0
    v_add_f32_dpp v5, v5, v5 quad_perm:[1,0,3,2] row_mask:0xf bank_mask:0xf
    s_nop 1
    v_add_f32_dpp v5, v5, v5 quad_perm:[2,3,0,1] row_mask:0xf bank_mask:0xf
    s_nop 1
    v_add_f32_dpp v5, v5, v5 row_half_mirror row_mask:0xf bank_mask:0xf
    s_nop 1
    v_add_f32_dpp v5, v5, v5 row_mirror row_mask:0xf bank_mask:0xf
    ds_write_b64 v14, v[4:5] offset:0
    s_waitcnt lgkmcnt(0)
    s_barrier
    s_load_dword s38, s[16:17], s36
    ds_read_b128 v[4:7], v3 offset:0
    s_waitcnt lgkmcnt(0)
    s_nop 0
    v_add_f32_dpp v8, v4, v4 quad_perm:[1,0,3,2] row_mask:0xf bank_mask:0xf
    v_add_f32_dpp v9, v6, v6 quad_perm:[1,0,3,2] row_mask:0xf bank_mask:0xf
    s_nop 0
    v_add_f32_dpp v8, v8, v8 quad_perm:[2,3,0,1] row_mask:0xf bank_mask:0xf
    v_add_f32_dpp v9, v9, v9 quad_perm:[2,3,0,1] row_mask:0xf bank_mask:0xf
    s_nop 0
    v_add_f32_dpp v8, v8, v8 row_half_mirror row_mask:0xf bank_mask:0xf
    v_add_f32_dpp v9, v9, v9 row_half_mirror row_mask:0xf bank_mask:0xf
    s_nop 0
    v_add_f32_dpp v8, v8, v8 row_mirror row_mask:0xf bank_mask:0xf
    v_add_f32_dpp v9, v9, v9 row_mirror row_mask:0xf bank_mask:0xf
    v_fmac_f32 v4, 0xbd800000, v8
    v_fmac_f32 v6, 0xbd800000, v9
    v_mul_f32 v10, 0x3a800000, v4
    v_mul_f32 v11, 0x3a800000, v6
    v_fmac_f32 v5, v10, v4
    v_fmac_f32 v7, v11, v6
    v_mov_b32 v4, v8
    v_mov_b32 v6, v9
    v_add_f32_dpp v5, v5, v5 quad_perm:[1,0,3,2] row_mask:0xf bank_mask:0xf
    v_add_f32_dpp v7, v7, v7 quad_perm:[1,0,3,2] row_mask:0xf bank_mask:0xf
    s_nop 0
    v_add_f32_dpp v5, v5, v5 quad_perm:[2,3,0,1] row_mask:0xf bank_mask:0xf
    v_add_f32_dpp v7, v7, v7 quad_perm:[2,3,0,1] row_mask:0xf bank_mask:0xf
    s_nop 0
    v_add_f32_dpp v5, v5, v5 row_half_mirror row_mask:0xf bank_mask:0xf
    v_add_f32_dpp v7, v7, v7 row_half_mirror row_mask:0xf bank_mask:0xf
    s_nop 0
    v_add_f32_dpp v5, v5, v5 row_mirror row_mask:0xf bank_mask:0xf
    v_add_f32_dpp v7, v7, v7 row_mirror row_mask:0xf bank_mask:0xf
    v_sub_f32 v8, v4, v6
    v_add_f32 v4, v4, v6
    v_add_f32 v5, v5, v7
    v_mul_f32 v9, 0x38000000, v8
    v_mul_f32 v6, 0x38000000, v4
    v_fmac_f32 v5, v9, v8
    v_cvt_pk_bf16_f32 v4, v6, v6
    v_lshlrev_b32 v4, 16, v4
    v_sub_f32 v6, v6, v4
    v_mul_f32 v6, v6, v6
    v_fmac_f32 v6, 0x38000000, v5
    v_max_f32 v5, 0, v6
    v_cvt_pk_bf16_f32 v5, v5, v5
    v_lshlrev_b32 v5, 16, v5
    v_add_f32 v5, 0x3727c5ac, v5
    v_cvt_pk_bf16_f32 v5, v5, v5
    v_lshlrev_b32 v5, 16, v5
    v_sqrt_f32 v5, v5
    s_nop 0
    v_cvt_pk_bf16_f32 v5, v5, v5
    v_lshlrev_b32 v5, 16, v5
    v_rcp_f32 v5, v5
    s_nop 0
    v_mul_f32 v24, s40, v5
    v_mul_f32 v26, s41, v5
    v_mul_f32 v28, s42, v5
    v_mul_f32 v30, s43, v5
    v_fma_f32 v25, -v4, v24, s32
    v_fma_f32 v27, -v4, v26, s33
    v_fma_f32 v29, -v4, v28, s34
    v_fma_f32 v31, -v4, v30, s35
    s_waitcnt lgkmcnt(0)
    s_cmp_eq_u32 s38, 0
    s_cbranch_scc1 L_dpoll
L_dgot:
    s_lshr_b32 s5, s2, 5
    s_xor_b32 s5, s5, s38
    s_lshr_b32 s37, s2, 2
    s_xor_b32 s5, s5, s37
    s_and_b32 s5, s5, 1
    s_andn2_b32 s45, s39, 4
    s_lshl2_add_u32 s45, s7, s45
    s_lshl2_add_u32 s45, s45, s6
    s_lshl1_add_u32 s45, s45, s5
    s_lshl_b32 s5, s45, 13
    s_add_u32 s5, s5, 0x2001000
    v_add_u32 v12, s5, v12
    v_add_u32 v13, 0x1000000, v12
    s_and_b32 s5, s45, 0xff
    s_lshl_b32 s5, s5, 3
    s_load_dwordx2 s[24:25], s[10:11], s5
    s_load_dwordx2 s[26:27], s[12:13], s5
    s_andn2_b32 s29, s2, 4
    s_lshl_b32 s29, s29, 8
    s_and_b32 s5, s2, 4
    s_lshl_b32 s5, s5, 5
    s_add_u32 s29, s29, s5
    s_xor_b32 s47, s29, 128
    v_xor_b32 v40, s29, v3
    s_cmp_lg_u32 s3, 0
    s_cbranch_scc1 L_notag
    s_mov_b64 exec, 0xffff
    global_load_dwordx4 v[32:35], v40, s[18:19] sc1
    s_mov_b64 exec, -1
L_notag:
    global_load_dwordx4 v[108:111], v12, s[8:9] offset:-4096 nt
    v_lshlrev_b32 v16, 16, v44
    v_and_b32 v17, s31, v44
    v_lshlrev_b32 v18, 16, v45
    v_and_b32 v19, s31, v45
    v_lshlrev_b32 v20, 16, v46
    v_and_b32 v21, s31, v46
    v_lshlrev_b32 v22, 16, v47
    v_and_b32 v23, s31, v47
    v_pk_fma_f32 v[16:17], v[16:17], v[24:25], v[24:25] op_sel:[0,0,1] op_sel_hi:[1,0,1]
    v_pk_fma_f32 v[18:19], v[18:19], v[24:25], v[24:25] op_sel:[0,0,1] op_sel_hi:[1,0,1]
    v_pk_fma_f32 v[20:21], v[20:21], v[24:25], v[24:25] op_sel:[0,0,1] op_sel_hi:[1,0,1]
    v_pk_fma_f32 v[22:23], v[22:23], v[24:25], v[24:25] op_sel:[0,0,1] op_sel_hi:[1,0,1]
    v_cvt_pk_bf16_f32 v44, v16, v17
    v_cvt_pk_bf16_f32 v45, v18, v19
    v_cvt_pk_bf16_f32 v46, v20, v21
    v_cvt_pk_bf16_f32 v47, v22, v23
    global_store_dwordx4 v1, v[44:47], s[14:15] offset:-4096 sc1
    global_load_dwordx4 v[112:115], v12, s[8:9] offset:-3072 nt
    v_lshlrev_b32 v16, 16, v48
    v_and_b32 v17, s31, v48
    v_lshlrev_b32 v18, 16, v49
    v_and_b32 v19, s31, v49
    v_lshlrev_b32 v20, 16, v50
    v_and_b32 v21, s31, v50
    v_lshlrev_b32 v22, 16, v51
    v_and_b32 v23, s31, v51
    v_pk_fma_f32 v[16:17], v[16:17], v[24:25], v[24:25] op_sel:[0,0,1] op_sel_hi:[1,0,1]
    v_pk_fma_f32 v[18:19], v[18:19], v[24:25], v[24:25] op_sel:[0,0,1] op_sel_hi:[1,0,1]
    v_pk_fma_f32 v[20:21], v[20:21], v[24:25], v[24:25] op_sel:[0,0,1] op_sel_hi:[1,0,1]
    v_pk_fma_f32 v[22:23], v[22:23], v[24:25], v[24:25] op_sel:[0,0,1] op_sel_hi:[1,0,1]
    v_cvt_pk_bf16_f32 v48, v16, v17
    v_cvt_pk_bf16_f32 v49, v18, v19
    v_cvt_pk_bf16_f32 v50, v20, v21
    v_cvt_pk_bf16_f32 v51, v22, v23
    global_store_dwordx4 v1, v[48:51], s[14:15] offset:-3072 sc1
    global_load_dwordx4 v[116:119], v12, s[8:9] offset:-2048 nt
    v_lshlrev_b32 v16, 16, v52
    v_and_b32 v17, s31, v52
    v_lshlrev_b32 v18, 16, v53
    v_and_b32 v19, s31, v53
    v_lshlrev_b32 v20, 16, v54
    v_and_b32 v21, s31, v54
    v_lshlrev_b32 v22, 16, v55
    v_and_b32 v23, s31, v55
    v_pk_fma_f32 v[16:17], v[16:17], v[26:27], v[26:27] op_sel:[0,0,1] op_sel_hi:[1,0,1]
    v_pk_fma_f32 v[18:19], v[18:19], v[26:27], v[26:27] op_sel:[0,0,1] op_sel_hi:[1,0,1]
    v_pk_fma_f32 v[20:21], v[20:21], v[26:27], v[26:27] op_sel:[0,0,1] op_sel_hi:[1,0,1]
    v_pk_fma_f32 v[22:23], v[22:23], v[26:27], v[26:27] op_sel:[0,0,1] op_sel_hi:[1,0,1]
    v_cvt_pk_bf16_f32 v52, v16, v17
    v_cvt_pk_bf16_f32 v53, v18, v19
    v_cvt_pk_bf16_f32 v54, v20, v21
    v_cvt_pk_bf16_f32 v55, v22, v23
    global_store_dwordx4 v1, v[52:55], s[14:15] offset:-2048 sc1
    global_load_dwordx4 v[120:123], v12, s[8:9] offset:-1024 nt
    v_lshlrev_b32 v16, 16, v56
    v_and_b32 v17, s31, v56
    v_lshlrev_b32 v18, 16, v57
    v_and_b32 v19, s31, v57
    v_lshlrev_b32 v20, 16, v58
    v_and_b32 v21, s31, v58
    v_lshlrev_b32 v22, 16, v59
    v_and_b32 v23, s31, v59
    v_pk_fma_f32 v[16:17], v[16:17], v[26:27], v[26:27] op_sel:[0,0,1] op_sel_hi:[1,0,1]
    v_pk_fma_f32 v[18:19], v[18:19], v[26:27], v[26:27] op_sel:[0,0,1] op_sel_hi:[1,0,1]
    v_pk_fma_f32 v[20:21], v[20:21], v[26:27], v[26:27] op_sel:[0,0,1] op_sel_hi:[1,0,1]
    v_pk_fma_f32 v[22:23], v[22:23], v[26:27], v[26:27] op_sel:[0,0,1] op_sel_hi:[1,0,1]
    v_cvt_pk_bf16_f32 v56, v16, v17
    v_cvt_pk_bf16_f32 v57, v18, v19
    v_cvt_pk_bf16_f32 v58, v20, v21
    v_cvt_pk_bf16_f32 v59, v22, v23
    global_store_dwordx4 v1, v[56:59], s[14:15] offset:-1024 sc1
    global_load_dwordx4 v[124:127], v12, s[8:9] offset:0 nt
    v_lshlrev_b32 v16, 16, v60
    v_and_b32 v17, s31, v60
    v_lshlrev_b32 v18, 16, v61
    v_and_b32 v19, s31, v61
    v_lshlrev_b32 v20, 16, v62
    v_and_b32 v21, s31, v62
    v_lshlrev_b32 v22, 16, v63
    v_and_b32 v23, s31, v63
    v_pk_fma_f32 v[16:17], v[16:17], v[28:29], v[28:29] op_sel:[0,0,1] op_sel_hi:[1,0,1]
    v_pk_fma_f32 v[18:19], v[18:19], v[28:29], v[28:29] op_sel:[0,0,1] op_sel_hi:[1,0,1]
    v_pk_fma_f32 v[20:21], v[20:21], v[28:29], v[28:29] op_sel:[0,0,1] op_sel_hi:[1,0,1]
    v_pk_fma_f32 v[22:23], v[22:23], v[28:29], v[28:29] op_sel:[0,0,1] op_sel_hi:[1,0,1]
    v_cvt_pk_bf16_f32 v60, v16, v17
    v_cvt_pk_bf16_f32 v61, v18, v19
    v_cvt_pk_bf16_f32 v62, v20, v21
    v_cvt_pk_bf16_f32 v63, v22, v23
    global_store_dwordx4 v1, v[60:63], s[14:15] offset:0 sc1
    global_load_dwordx4 v[128:131], v12, s[8:9] offset:1024 nt
    v_lshlrev_b32 v16, 16, v64
    v_and_b32 v17, s31, v64
    v_lshlrev_b32 v18, 16, v65
    v_and_b32 v19, s31, v65
    v_lshlrev_b32 v20, 16, v66
    v_and_b32 v21, s31, v66
    v_lshlrev_b32 v22, 16, v67
    v_and_b32 v23, s31, v67
    v_pk_fma_f32 v[16:17], v[16:17], v[28:29], v[28:29] op_sel:[0,0,1] op_sel_hi:[1,0,1]
    v_pk_fma_f32 v[18:19], v[18:19], v[28:29], v[28:29] op_sel:[0,0,1] op_sel_hi:[1,0,1]
    v_pk_fma_f32 v[20:21], v[20:21], v[28:29], v[28:29] op_sel:[0,0,1] op_sel_hi:[1,0,1]
    v_pk_fma_f32 v[22:23], v[22:23], v[28:29], v[28:29] op_sel:[0,0,1] op_sel_hi:[1,0,1]
    v_cvt_pk_bf16_f32 v64, v16, v17
    v_cvt_pk_bf16_f32 v65, v18, v19
    v_cvt_pk_bf16_f32 v66, v20, v21
    v_cvt_pk_bf16_f32 v67, v22, v23
    global_store_dwordx4 v1, v[64:67], s[14:15] offset:1024 sc1
    global_load_dwordx4 v[132:135], v12, s[8:9] offset:2048 nt
    v_lshlrev_b32 v16, 16, v68
    v_and_b32 v17, s31, v68
    v_lshlrev_b32 v18, 16, v69
    v_and_b32 v19, s31, v69
    v_lshlrev_b32 v20, 16, v70
    v_and_b32 v21, s31, v70
    v_lshlrev_b32 v22, 16, v71
    v_and_b32 v23, s31, v71
    v_pk_fma_f32 v[16:17], v[16:17], v[30:31], v[30:31] op_sel:[0,0,1] op_sel_hi:[1,0,1]
    v_pk_fma_f32 v[18:19], v[18:19], v[30:31], v[30:31] op_sel:[0,0,1] op_sel_hi:[1,0,1]
    v_pk_fma_f32 v[20:21], v[20:21], v[30:31], v[30:31] op_sel:[0,0,1] op_sel_hi:[1,0,1]
    v_pk_fma_f32 v[22:23], v[22:23], v[30:31], v[30:31] op_sel:[0,0,1] op_sel_hi:[1,0,1]
    v_cvt_pk_bf16_f32 v68, v16, v17
    v_cvt_pk_bf16_f32 v69, v18, v19
    v_cvt_pk_bf16_f32 v70, v20, v21
    v_cvt_pk_bf16_f32 v71, v22, v23
    global_store_dwordx4 v1, v[68:71], s[14:15] offset:2048 sc1
    global_load_dwordx4 v[136:139], v12, s[8:9] offset:3072 nt
    v_lshlrev_b32 v16, 16, v72
    v_and_b32 v17, s31, v72
    v_lshlrev_b32 v18, 16, v73
    v_and_b32 v19, s31, v73
    v_lshlrev_b32 v20, 16, v74
    v_and_b32 v21, s31, v74
    v_lshlrev_b32 v22, 16, v75
    v_and_b32 v23, s31, v75
    v_pk_fma_f32 v[16:17], v[16:17], v[30:31], v[30:31] op_sel:[0,0,1] op_sel_hi:[1,0,1]
    v_pk_fma_f32 v[18:19], v[18:19], v[30:31], v[30:31] op_sel:[0,0,1] op_sel_hi:[1,0,1]
    v_pk_fma_f32 v[20:21], v[20:21], v[30:31], v[30:31] op_sel:[0,0,1] op_sel_hi:[1,0,1]
    v_pk_fma_f32 v[22:23], v[22:23], v[30:31], v[30:31] op_sel:[0,0,1] op_sel_hi:[1,0,1]
    v_cvt_pk_bf16_f32 v72, v16, v17
    v_cvt_pk_bf16_f32 v73, v18, v19
    v_cvt_pk_bf16_f32 v74, v20, v21
    v_cvt_pk_bf16_f32 v75, v22, v23
    global_store_dwordx4 v1, v[72:75], s[14:15] offset:3072 sc1
    s_waitcnt vmcnt(16) lgkmcnt(0)
    s_lshl_b32 s64, s24, 16
    s_lshl_b32 s68, s26, 16
    s_and_b32 s65, s24, s31
    s_and_b32 s69, s26, s31
    s_lshl_b32 s66, s25, 16
    s_lshl_b32 s70, s27, 16
    s_and_b32 s67, s25, s31
    s_and_b32 s71, s27, s31
    v_add_u32 v33, 1, v33
    v_add_u32 v35, 1, v35
    v_mov_b32 v4, 0
    v_mov_b32 v5, 0
    s_waitcnt vmcnt(23)
    v_dot2c_f32_bf16 v4, s30, v76
    v_dot2c_f32_bf16 v5, v76, v76
    v_dot2c_f32_bf16 v4, s30, v77
    v_dot2c_f32_bf16 v5, v77, v77
    v_dot2c_f32_bf16 v4, s30, v78
    v_dot2c_f32_bf16 v5, v78, v78
    v_dot2c_f32_bf16 v4, s30, v79
    v_dot2c_f32_bf16 v5, v79, v79
    s_waitcnt vmcnt(22)
    v_dot2c_f32_bf16 v4, s30, v80
    v_dot2c_f32_bf16 v5, v80, v80
    v_dot2c_f32_bf16 v4, s30, v81
    v_dot2c_f32_bf16 v5, v81, v81
    v_dot2c_f32_bf16 v4, s30, v82
    v_dot2c_f32_bf16 v5, v82, v82
    v_dot2c_f32_bf16 v4, s30, v83
    v_dot2c_f32_bf16 v5, v83, v83
    s_waitcnt vmcnt(21)
    v_dot2c_f32_bf16 v4, s30, v84
    v_dot2c_f32_bf16 v5, v84, v84
    v_dot2c_f32_bf16 v4, s30, v85
    v_dot2c_f32_bf16 v5, v85, v85
    v_dot2c_f32_bf16 v4, s30, v86
    v_dot2c_f32_bf16 v5, v86, v86
    v_dot2c_f32_bf16 v4, s30, v87
    v_dot2c_f32_bf16 v5, v87, v87
    s_waitcnt vmcnt(20)
    v_dot2c_f32_bf16 v4, s30, v88
    v_dot2c_f32_bf16 v5, v88, v88
    v_dot2c_f32_bf16 v4, s30, v89
    v_dot2c_f32_bf16 v5, v89, v89
    v_dot2c_f32_bf16 v4, s30, v90
    v_dot2c_f32_bf16 v5, v90, v90
    v_dot2c_f32_bf16 v4, s30, v91
    v_dot2c_f32_bf16 v5, v91, v91
    s_waitcnt vmcnt(19)
    v_dot2c_f32_bf16 v4, s30, v92
    v_dot2c_f32_bf16 v5, v92, v92
    v_dot2c_f32_bf16 v4, s30, v93
    v_dot2c_f32_bf16 v5, v93, v93
    v_dot2c_f32_bf16 v4, s30, v94
    v_dot2c_f32_bf16 v5, v94, v94
    v_dot2c_f32_bf16 v4, s30, v95
    v_dot2c_f32_bf16 v5, v95, v95
    s_waitcnt vmcnt(18)
    v_dot2c_f32_bf16 v4, s30, v96
    v_dot2c_f32_bf16 v5, v96, v96
    v_dot2c_f32_bf16 v4, s30, v97
    v_dot2c_f32_bf16 v5, v97, v97
    v_dot2c_f32_bf16 v4, s30, v98
    v_dot2c_f32_bf16 v5, v98, v98
    v_dot2c_f32_bf16 v4, s30, v99
    v_dot2c_f32_bf16 v5, v99, v99
    s_waitcnt vmcnt(17)
    v_dot2c_f32_bf16 v4, s30, v100
    v_dot2c_f32_bf16 v5, v100, v100
    v_dot2c_f32_bf16 v4, s30, v101
    v_dot2c_f32_bf16 v5, v101, v101
    v_dot2c_f32_bf16 v4, s30, v102
    v_dot2c_f32_bf16 v5, v102, v102
    v_dot2c_f32_bf16 v4, s30, v103
    v_dot2c_f32_bf16 v5, v103, v103
    s_waitcnt vmcnt(16)
    v_dot2c_f32_bf16 v4, s30, v104
    v_dot2c_f32_bf16 v5, v104, v104
    v_dot2c_f32_bf16 v4, s30, v105
    v_dot2c_f32_bf16 v5, v105, v105
    v_dot2c_f32_bf16 v4, s30, v106
    v_dot2c_f32_bf16 v5, v106, v106
    v_dot2c_f32_bf16 v4, s30, v107
    v_dot2c_f32_bf16 v5, v107, v107
    s_nop 1
    v_mul_f32 v10, 0xbc800000, v4
    v_add_f32_dpp v8, v4, v4 quad_perm:[1,0,3,2] row_mask:0xf bank_mask:0xf
    v_fmac_f32 v5, v10, v4
    s_nop 0
    v_add_f32_dpp v8, v8, v8 quad_perm:[2,3,0,1] row_mask:0xf bank_mask:0xf
    s_nop 1
    v_add_f32_dpp v8, v8, v8 row_half_mirror row_mask:0xf bank_mask:0xf
    s_nop 1
    v_add_f32_dpp v8, v8, v8 row_mirror row_mask:0xf bank_mask:0xf
    v_fmac_f32 v4, 0xbd800000, v8
    v_mul_f32 v10, 0x3c800000, v4
    v_fmac_f32 v5, v10, v4
    v_mov_b32 v4, v8
    s_nop 0
    v_add_f32_dpp v5, v5, v5 quad_perm:[1,0,3,2] row_mask:0xf bank_mask:0xf
    s_nop 1
    v_add_f32_dpp v5, v5, v5 quad_perm:[2,3,0,1] row_mask:0xf bank_mask:0xf
    s_nop 1
    v_add_f32_dpp v5, v5, v5 row_half_mirror row_mask:0xf bank_mask:0xf
    s_nop 1
    v_add_f32_dpp v5, v5, v5 row_mirror row_mask:0xf bank_mask:0xf
    ds_write_b64 v14, v[4:5] offset:256
    s_waitcnt lgkmcnt(0)
    s_barrier
    ds_read_b128 v[4:7], v3 offset:256
    s_waitcnt lgkmcnt(0)
    s_nop 0
    v_add_f32_dpp v8, v4, v4 quad_perm:[1,0,3,2] row_mask:0xf bank_mask:0xf
    v_add_f32_dpp v9, v6, v6 quad_perm:[1,0,3,2] row_mask:0xf bank_mask:0xf
    s_nop 0
    v_add_f32_dpp v8, v8, v8 quad_perm:[2,3,0,1] row_mask:0xf bank_mask:0xf
    v_add_f32_dpp v9, v9, v9 quad_perm:[2,3,0,1] row_mask:0xf bank_mask:0xf
    s_nop 0
    v_add_f32_dpp v8, v8, v8 row_half_mirror row_mask:0xf bank_mask:0xf
    v_add_f32_dpp v9, v9, v9 row_half_mirror row_mask:0xf bank_mask:0xf
    s_nop 0
    v_add_f32_dpp v8, v8, v8 row_mirror row_mask:0xf bank_mask:0xf
    v_add_f32_dpp v9, v9, v9 row_mirror row_mask:0xf bank_mask:0xf
    v_fmac_f32 v4, 0xbd800000, v8
    v_fmac_f32 v6, 0xbd800000, v9
    v_mul_f32 v10, 0x3a800000, v4
    v_mul_f32 v11, 0x3a800000, v6
    v_fmac_f32 v5, v10, v4
    v_fmac_f32 v7, v11, v6
    v_mov_b32 v4, v8
    v_mov_b32 v6, v9
    v_add_f32_dpp v5, v5, v5 quad_perm:[1,0,3,2] row_mask:0xf bank_mask:0xf
    v_add_f32_dpp v7, v7, v7 quad_perm:[1,0,3,2] row_mask:0xf bank_mask:0xf
    s_nop 0
    v_add_f32_dpp v5, v5, v5 quad_perm:[2,3,0,1] row_mask:0xf bank_mask:0xf
    v_add_f32_dpp v7, v7, v7 quad_perm:[2,3,0,1] row_mask:0xf bank_mask:0xf
    s_nop 0
    v_add_f32_dpp v5, v5, v5 row_half_mirror row_mask:0xf bank_mask:0xf
    v_add_f32_dpp v7, v7, v7 row_half_mirror row_mask:0xf bank_mask:0xf
    s_nop 0
    v_add_f32_dpp v5, v5, v5 row_mirror row_mask:0xf bank_mask:0xf
    v_add_f32_dpp v7, v7, v7 row_mirror row_mask:0xf bank_mask:0xf
    v_sub_f32 v8, v4, v6
    v_add_f32 v4, v4, v6
    v_add_f32 v5, v5, v7
    v_mul_f32 v9, 0x38000000, v8
    v_mul_f32 v6, 0x38000000, v4
    v_fmac_f32 v5, v9, v8
    v_cvt_pk_bf16_f32 v4, v6, v6
    v_lshlrev_b32 v4, 16, v4
    v_sub_f32 v6, v6, v4
    v_mul_f32 v6, v6, v6
    v_fmac_f32 v6, 0x38000000, v5
    v_max_f32 v5, 0, v6
    v_cvt_pk_bf16_f32 v5, v5, v5
    v_lshlrev_b32 v5, 16, v5
    v_add_f32 v5, 0x3727c5ac, v5
    v_cvt_pk_bf16_f32 v5, v5, v5
    v_lshlrev_b32 v5, 16, v5
    v_sqrt_f32 v5, v5
    s_nop 0
    v_cvt_pk_bf16_f32 v5, v5, v5
    v_lshlrev_b32 v5, 16, v5
    v_rcp_f32 v5, v5
    s_nop 0
    v_mul_f32 v24, s40, v5
    v_mul_f32 v26, s41, v5
    v_mul_f32 v28, s42, v5
    v_mul_f32 v30, s43, v5
    v_fma_f32 v25, -v4, v24, s32
    v_fma_f32 v27, -v4, v26, s33
    v_fma_f32 v29, -v4, v28, s34
    v_fma_f32 v31, -v4, v30, s35
    v_lshlrev_b32 v16, 16, v76
    v_and_b32 v17, s31, v76
    v_lshlrev_b32 v18, 16, v77
    v_and_b32 v19, s31, v77
    v_lshlrev_b32 v20, 16, v78
    v_and_b32 v21, s31, v78
    v_lshlrev_b32 v22, 16, v79
    v_and_b32 v23, s31, v79
    v_pk_fma_f32 v[16:17], v[16:17], v[24:25], v[24:25] op_sel:[0,0,1] op_sel_hi:[1,0,1]
    v_pk_fma_f32 v[18:19], v[18:19], v[24:25], v[24:25] op_sel:[0,0,1] op_sel_hi:[1,0,1]
    v_pk_fma_f32 v[20:21], v[20:21], v[24:25], v[24:25] op_sel:[0,0,1] op_sel_hi:[1,0,1]
    v_pk_fma_f32 v[22:23], v[22:23], v[24:25], v[24:25] op_sel:[0,0,1] op_sel_hi:[1,0,1]
    v_cvt_pk_bf16_f32 v76, v16, v17
    v_cvt_pk_bf16_f32 v77, v18, v19
    v_cvt_pk_bf16_f32 v78, v20, v21
    v_cvt_pk_bf16_f32 v79, v22, v23
    global_store_dwordx4 v2, v[76:79], s[14:15] offset:-4096 sc1
    global_load_dwordx4 v[140:143], v13, s[8:9] offset:-4096 nt
    v_lshlrev_b32 v16, 16, v80
    v_and_b32 v17, s31, v80
    v_lshlrev_b32 v18, 16, v81
    v_and_b32 v19, s31, v81
    v_lshlrev_b32 v20, 16, v82
    v_and_b32 v21, s31, v82
    v_lshlrev_b32 v22, 16, v83
    v_and_b32 v23, s31, v83
    v_pk_fma_f32 v[16:17], v[16:17], v[24:25], v[24:25] op_sel:[0,0,1] op_sel_hi:[1,0,1]
    v_pk_fma_f32 v[18:19], v[18:19], v[24:25], v[24:25] op_sel:[0,0,1] op_sel_hi:[1,0,1]
    v_pk_fma_f32 v[20:21], v[20:21], v[24:25], v[24:25] op_sel:[0,0,1] op_sel_hi:[1,0,1]
    v_pk_fma_f32 v[22:23], v[22:23], v[24:25], v[24:25] op_sel:[0,0,1] op_sel_hi:[1,0,1]
    v_cvt_pk_bf16_f32 v80, v16, v17
    v_cvt_pk_bf16_f32 v81, v18, v19
    v_cvt_pk_bf16_f32 v82, v20, v21
    v_cvt_pk_bf16_f32 v83, v22, v23
    global_store_dwordx4 v2, v[80:83], s[14:15] offset:-3072 sc1
    global_load_dwordx4 v[144:147], v13, s[8:9] offset:-3072 nt
    v_lshlrev_b32 v16, 16, v84
    v_and_b32 v17, s31, v84
    v_lshlrev_b32 v18, 16, v85
    v_and_b32 v19, s31, v85
    v_lshlrev_b32 v20, 16, v86
    v_and_b32 v21, s31, v86
    v_lshlrev_b32 v22, 16, v87
    v_and_b32 v23, s31, v87
    v_pk_fma_f32 v[16:17], v[16:17], v[26:27], v[26:27] op_sel:[0,0,1] op_sel_hi:[1,0,1]
    v_pk_fma_f32 v[18:19], v[18:19], v[26:27], v[26:27] op_sel:[0,0,1] op_sel_hi:[1,0,1]
    v_pk_fma_f32 v[20:21], v[20:21], v[26:27], v[26:27] op_sel:[0,0,1] op_sel_hi:[1,0,1]
    v_pk_fma_f32 v[22:23], v[22:23], v[26:27], v[26:27] op_sel:[0,0,1] op_sel_hi:[1,0,1]
    v_cvt_pk_bf16_f32 v84, v16, v17
    v_cvt_pk_bf16_f32 v85, v18, v19
    v_cvt_pk_bf16_f32 v86, v20, v21
    v_cvt_pk_bf16_f32 v87, v22, v23
    global_store_dwordx4 v2, v[84:87], s[14:15] offset:-2048 sc1
    global_load_dwordx4 v[148:151], v13, s[8:9] offset:-2048 nt
    v_lshlrev_b32 v16, 16, v88
    v_and_b32 v17, s31, v88
    v_lshlrev_b32 v18, 16, v89
    v_and_b32 v19, s31, v89
    v_lshlrev_b32 v20, 16, v90
    v_and_b32 v21, s31, v90
    v_lshlrev_b32 v22, 16, v91
    v_and_b32 v23, s31, v91
    v_pk_fma_f32 v[16:17], v[16:17], v[26:27], v[26:27] op_sel:[0,0,1] op_sel_hi:[1,0,1]
    v_pk_fma_f32 v[18:19], v[18:19], v[26:27], v[26:27] op_sel:[0,0,1] op_sel_hi:[1,0,1]
    v_pk_fma_f32 v[20:21], v[20:21], v[26:27], v[26:27] op_sel:[0,0,1] op_sel_hi:[1,0,1]
    v_pk_fma_f32 v[22:23], v[22:23], v[26:27], v[26:27] op_sel:[0,0,1] op_sel_hi:[1,0,1]
    v_cvt_pk_bf16_f32 v88, v16, v17
    v_cvt_pk_bf16_f32 v89, v18, v19
    v_cvt_pk_bf16_f32 v90, v20, v21
    v_cvt_pk_bf16_f32 v91, v22, v23
    global_store_dwordx4 v2, v[88:91], s[14:15] offset:-1024 sc1
    global_load_dwordx4 v[152:155], v13, s[8:9] offset:-1024 nt
    v_mov_b32 v4, 0
    v_mov_b32 v5, 0
    s_waitcnt vmcnt(23)
    v_dot2c_f32_bf16 v4, s30, v108
    v_dot2c_f32_bf16 v5, v108, v108
    v_dot2c_f32_bf16 v4, s30, v109
    v_dot2c_f32_bf16 v5, v109, v109
    v_dot2c_f32_bf16 v4, s30, v110
    v_dot2c_f32_bf16 v5, v110, v110
    v_dot2c_f32_bf16 v4, s30, v111
    v_dot2c_f32_bf16 v5, v111, v111
    s_waitcnt vmcnt(21)
    v_dot2c_f32_bf16 v4, s30, v112
    v_dot2c_f32_bf16 v5, v112, v112
    v_dot2c_f32_bf16 v4, s30, v113
    v_dot2c_f32_bf16 v5, v113, v113
    v_dot2c_f32_bf16 v4, s30, v114
    v_dot2c_f32_bf16 v5, v114, v114
    v_dot2c_f32_bf16 v4, s30, v115
    v_dot2c_f32_bf16 v5, v115, v115
    s_waitcnt vmcnt(19)
    v_dot2c_f32_bf16 v4, s30, v116
    v_dot2c_f32_bf16 v5, v116, v116
    v_dot2c_f32_bf16 v4, s30, v117
    v_dot2c_f32_bf16 v5, v117, v117
    v_dot2c_f32_bf16 v4, s30, v118
    v_dot2c_f32_bf16 v5, v118, v118
    v_dot2c_f32_bf16 v4, s30, v119
    v_dot2c_f32_bf16 v5, v119, v119
    s_waitcnt vmcnt(17)
    v_dot2c_f32_bf16 v4, s30, v120
    v_dot2c_f32_bf16 v5, v120, v120
    v_dot2c_f32_bf16 v4, s30, v121
    v_dot2c_f32_bf16 v5, v121, v121
    v_dot2c_f32_bf16 v4, s30, v122
    v_dot2c_f32_bf16 v5, v122, v122
    v_dot2c_f32_bf16 v4, s30, v123
    v_dot2c_f32_bf16 v5, v123, v123
    s_waitcnt vmcnt(15)
    v_dot2c_f32_bf16 v4, s30, v124
    v_dot2c_f32_bf16 v5, v124, v124
    v_dot2c_f32_bf16 v4, s30, v125
    v_dot2c_f32_bf16 v5, v125, v125
    v_dot2c_f32_bf16 v4, s30, v126
    v_dot2c_f32_bf16 v5, v126, v126
    v_dot2c_f32_bf16 v4, s30, v127
    v_dot2c_f32_bf16 v5, v127, v127
    s_waitcnt vmcnt(13)
    v_dot2c_f32_bf16 v4, s30, v128
    v_dot2c_f32_bf16 v5, v128, v128
    v_dot2c_f32_bf16 v4, s30, v129
    v_dot2c_f32_bf16 v5, v129, v129
    v_dot2c_f32_bf16 v4, s30, v130
    v_dot2c_f32_bf16 v5, v130, v130
    v_dot2c_f32_bf16 v4, s30, v131
    v_dot2c_f32_bf16 v5, v131, v131
    s_waitcnt vmcnt(11)
    v_dot2c_f32_bf16 v4, s30, v132
    v_dot2c_f32_bf16 v5, v132, v132
    v_dot2c_f32_bf16 v4, s30, v133
    v_dot2c_f32_bf16 v5, v133, v133
    v_dot2c_f32_bf16 v4, s30, v134
    v_dot2c_f32_bf16 v5, v134, v134
    v_dot2c_f32_bf16 v4, s30, v135
    v_dot2c_f32_bf16 v5, v135, v135
    s_waitcnt vmcnt(9)
    v_dot2c_f32_bf16 v4, s30, v136
    v_dot2c_f32_bf16 v5, v136, v136
    v_dot2c_f32_bf16 v4, s30, v137
    v_dot2c_f32_bf16 v5, v137, v137
    v_dot2c_f32_bf16 v4, s30, v138
    v_dot2c_f32_bf16 v5, v138, v138
    v_dot2c_f32_bf16 v4, s30, v139
    v_dot2c_f32_bf16 v5, v139, v139
    s_nop 1
    v_mul_f32 v10, 0xbc800000, v4
    v_add_f32_dpp v8, v4, v4 quad_perm:[1,0,3,2] row_mask:0xf bank_mask:0xf
    v_fmac_f32 v5, v10, v4
    s_nop 0
    v_add_f32_dpp v8, v8, v8 quad_perm:[2,3,0,1] row_mask:0xf bank_mask:0xf
    s_nop 1
    v_add_f32_dpp v8, v8, v8 row_half_mirror row_mask:0xf bank_mask:0xf
    s_nop 1
    v_add_f32_dpp v8, v8, v8 row_mirror row_mask:0xf bank_mask:0xf
    v_fmac_f32 v4, 0xbd800000, v8
    v_mul_f32 v10, 0x3c800000, v4
    v_fmac_f32 v5, v10, v4
    v_mov_b32 v4, v8
    s_nop 0
    v_add_f32_dpp v5, v5, v5 quad_perm:[1,0,3,2] row_mask:0xf bank_mask:0xf
    s_nop 1
    v_add_f32_dpp v5, v5, v5 quad_perm:[2,3,0,1] row_mask:0xf bank_mask:0xf
    s_nop 1
    v_add_f32_dpp v5, v5, v5 row_half_mirror row_mask:0xf bank_mask:0xf
    s_nop 1
    v_add_f32_dpp v5, v5, v5 row_mirror row_mask:0xf bank_mask:0xf
    ds_write_b64 v14, v[4:5] offset:512
    s_waitcnt lgkmcnt(0)
    s_barrier
    s_cmp_lg_u32 s3, 0
    s_cbranch_scc1 L_np1
    ds_read_b128 v[4:7], v3 offset:512
    s_waitcnt lgkmcnt(0)
    s_nop 0
    v_add_f32_dpp v8, v4, v4 quad_perm:[1,0,3,2] row_mask:0xf bank_mask:0xf
    v_add_f32_dpp v9, v6, v6 quad_perm:[1,0,3,2] row_mask:0xf bank_mask:0xf
    s_nop 0
    v_add_f32_dpp v8, v8, v8 quad_perm:[2,3,0,1] row_mask:0xf bank_mask:0xf
    v_add_f32_dpp v9, v9, v9 quad_perm:[2,3,0,1] row_mask:0xf bank_mask:0xf
    s_nop 0
    v_add_f32_dpp v8, v8, v8 row_half_mirror row_mask:0xf bank_mask:0xf
    v_add_f32_dpp v9, v9, v9 row_half_mirror row_mask:0xf bank_mask:0xf
    s_nop 0
    v_add_f32_dpp v8, v8, v8 row_mirror row_mask:0xf bank_mask:0xf
    v_add_f32_dpp v9, v9, v9 row_mirror row_mask:0xf bank_mask:0xf
    v_fmac_f32 v4, 0xbd800000, v8
    v_fmac_f32 v6, 0xbd800000, v9
    v_mul_f32 v10, 0x3a800000, v4
    v_mul_f32 v11, 0x3a800000, v6
    v_fmac_f32 v5, v10, v4
    v_fmac_f32 v7, v11, v6
    v_mov_b32 v4, v8
    v_mov_b32 v6, v9
    v_add_f32_dpp v5, v5, v5 quad_perm:[1,0,3,2] row_mask:0xf bank_mask:0xf
    v_add_f32_dpp v7, v7, v7 quad_perm:[1,0,3,2] row_mask:0xf bank_mask:0xf
    s_nop 0
    v_add_f32_dpp v5, v5, v5 quad_perm:[2,3,0,1] row_mask:0xf bank_mask:0xf
    v_add_f32_dpp v7, v7, v7 quad_perm:[2,3,0,1] row_mask:0xf bank_mask:0xf
    s_nop 0
    v_add_f32_dpp v5, v5, v5 row_half_mirror row_mask:0xf bank_mask:0xf
    v_add_f32_dpp v7, v7, v7 row_half_mirror row_mask:0xf bank_mask:0xf
    s_nop 0
    v_add_f32_dpp v5, v5, v5 row_mirror row_mask:0xf bank_mask:0xf
    v_add_f32_dpp v7, v7, v7 row_mirror row_mask:0xf bank_mask:0xf
    v_cndmask_b32 v32, v4, v6, vcc
    v_cndmask_b32 v34, v5, v7, vcc
    s_mov_b64 exec, 0x30
    global_store_dwordx4 v40, v[32:35], s[18:19] sc1
    s_mov_b64 exec, -1
    v_mov_b32 v41, v32
    v_mov_b32 v42, v34
L_np1:
    global_load_dwordx4 v[156:159], v13, s[8:9] offset:0 nt
    v_lshlrev_b32 v16, 16, v92
    v_and_b32 v17, s31, v92
    v_lshlrev_b32 v18, 16, v93
    v_and_b32 v19, s31, v93
    v_lshlrev_b32 v20, 16, v94
    v_and_b32 v21, s31, v94
    v_lshlrev_b32 v22, 16, v95
    v_and_b32 v23, s31, v95
    v_pk_fma_f32 v[16:17], v[16:17], v[28:29], v[28:29] op_sel:[0,0,1] op_sel_hi:[1,0,1]
    v_pk_fma_f32 v[18:19], v[18:19], v[28:29], v[28:29] op_sel:[0,0,1] op_sel_hi:[1,0,1]
    v_pk_fma_f32 v[20:21], v[20:21], v[28:29], v[28:29] op_sel:[0,0,1] op_sel_hi:[1,0,1]
    v_pk_fma_f32 v[22:23], v[22:23], v[28:29], v[28:29] op_sel:[0,0,1] op_sel_hi:[1,0,1]
    v_cvt_pk_bf16_f32 v92, v16, v17
    v_cvt_pk_bf16_f32 v93, v18, v19
    v_cvt_pk_bf16_f32 v94, v20, v21
    v_cvt_pk_bf16_f32 v95, v22, v23
    global_store_dwordx4 v2, v[92:95], s[14:15] offset:0 sc1
    v_lshlrev_b32 v16, 16, v96
    v_and_b32 v17, s31, v96
    v_lshlrev_b32 v18, 16, v97
    v_and_b32 v19, s31, v97
    v_lshlrev_b32 v20, 16, v98
    v_and_b32 v21, s31, v98
    v_lshlrev_b32 v22, 16, v99
    v_and_b32 v23, s31, v99
    v_pk_fma_f32 v[16:17], v[16:17], v[28:29], v[28:29] op_sel:[0,0,1] op_sel_hi:[1,0,1]
    v_pk_fma_f32 v[18:19], v[18:19], v[28:29], v[28:29] op_sel:[0,0,1] op_sel_hi:[1,0,1]
    v_pk_fma_f32 v[20:21], v[20:21], v[28:29], v[28:29] op_sel:[0,0,1] op_sel_hi:[1,0,1]
    v_pk_fma_f32 v[22:23], v[22:23], v[28:29], v[28:29] op_sel:[0,0,1] op_sel_hi:[1,0,1]
    v_cvt_pk_bf16_f32 v96, v16, v17
    v_cvt_pk_bf16_f32 v97, v18, v19
    v_cvt_pk_bf16_f32 v98, v20, v21
    v_cvt_pk_bf16_f32 v99, v22, v23
    global_store_dwordx4 v2, v[96:99], s[14:15] offset:1024 sc1
    v_lshlrev_b32 v16, 16, v100
    v_and_b32 v17, s31, v100
    v_lshlrev_b32 v18, 16, v101
    v_and_b32 v19, s31, v101
    v_lshlrev_b32 v20, 16, v102
    v_and_b32 v21, s31, v102
    v_lshlrev_b32 v22, 16, v103
    v_and_b32 v23, s31, v103
    v_pk_fma_f32 v[16:17], v[16:17], v[30:31], v[30:31] op_sel:[0,0,1] op_sel_hi:[1,0,1]
    v_pk_fma_f32 v[18:19], v[18:19], v[30:31], v[30:31] op_sel:[0,0,1] op_sel_hi:[1,0,1]
    v_pk_fma_f32 v[20:21], v[20:21], v[30:31], v[30:31] op_sel:[0,0,1] op_sel_hi:[1,0,1]
    v_pk_fma_f32 v[22:23], v[22:23], v[30:31], v[30:31] op_sel:[0,0,1] op_sel_hi:[1,0,1]
    v_cvt_pk_bf16_f32 v100, v16, v17
    v_cvt_pk_bf16_f32 v101, v18, v19
    v_cvt_pk_bf16_f32 v102, v20, v21
    v_cvt_pk_bf16_f32 v103, v22, v23
    global_store_dwordx4 v2, v[100:103], s[14:15] offset:2048 sc1
    v_lshlrev_b32 v16, 16, v104
    v_and_b32 v17, s31, v104
    v_lshlrev_b32 v18, 16, v105
    v_and_b32 v19, s31, v105
    v_lshlrev_b32 v20, 16, v106
    v_and_b32 v21, s31, v106
    v_lshlrev_b32 v22, 16, v107
    v_and_b32 v23, s31, v107
    v_pk_fma_f32 v[16:17], v[16:17], v[30:31], v[30:31] op_sel:[0,0,1] op_sel_hi:[1,0,1]
    v_pk_fma_f32 v[18:19], v[18:19], v[30:31], v[30:31] op_sel:[0,0,1] op_sel_hi:[1,0,1]
    v_pk_fma_f32 v[20:21], v[20:21], v[30:31], v[30:31] op_sel:[0,0,1] op_sel_hi:[1,0,1]
    v_pk_fma_f32 v[22:23], v[22:23], v[30:31], v[30:31] op_sel:[0,0,1] op_sel_hi:[1,0,1]
    v_cvt_pk_bf16_f32 v104, v16, v17
    v_cvt_pk_bf16_f32 v105, v18, v19
    v_cvt_pk_bf16_f32 v106, v20, v21
    v_cvt_pk_bf16_f32 v107, v22, v23
    global_store_dwordx4 v2, v[104:107], s[14:15] offset:3072 sc1
    s_cmp_lg_u32 s3, 0
    s_cbranch_scc1 L_j2
    v_readlane_b32 s56, v33, 12
    v_readlane_b32 s57, v35, 12
    v_readlane_b32 s58, v33, 13
    v_readlane_b32 s59, v35, 13
    s_movk_i32 s46, 160
    s_load_dwordx8 s[48:55], s[18:19], s47 offset:64 glc
L_pp2:
    s_waitcnt lgkmcnt(0)
    s_xor_b32 s5, s49, s56
    s_xor_b32 s28, s51, s57
    s_or_b32 s5, s5, s28
    s_xor_b32 s28, s53, s58
    s_or_b32 s5, s5, s28
    s_xor_b32 s28, s55, s59
    s_or_b32 s5, s5, s28
    s_cbranch_scc1 L_pm2
    v_mov_b32 v6, s48
    v_mov_b32 v7, s50
    v_writelane_b32 v6, s52, 1
    v_writelane_b32 v7, s54, 1
L_mg2:
    v_mov_b32 v4, v41
    v_mov_b32 v5, v42
    v_sub_f32 v8, v4, v6
    v_add_f32 v4, v4, v6
    v_add_f32 v5, v5, v7
    v_mul_f32 v9, 0x38000000, v8
    v_mul_f32 v6, 0x38000000, v4
    v_fmac_f32 v5, v9, v8
    v_cvt_pk_bf16_f32 v4, v6, v6
    v_lshlrev_b32 v4, 16, v4
    v_sub_f32 v6, v6, v4
    v_mul_f32 v6, v6, v6
    v_fmac_f32 v6, 0x38000000, v5
    v_max_f32 v5, 0, v6
    v_cvt_pk_bf16_f32 v5, v5, v5
    v_lshlrev_b32 v5, 16, v5
    v_add_f32 v5, 0x3727c5ac, v5
    v_cvt_pk_bf16_f32 v5, v5, v5
    v_lshlrev_b32 v5, 16, v5
    v_sqrt_f32 v5, v5
    s_nop 0
    v_cvt_pk_bf16_f32 v5, v5, v5
    v_lshlrev_b32 v5, 16, v5
    v_rcp_f32 v5, v5
    s_nop 0
    v_lshlrev_b32 v8, 3, v0
    s_mov_b64 exec, 3
    ds_write_b64 v8, v[4:5] offset:1056
    s_mov_b64 exec, -1
    s_waitcnt lgkmcnt(0)
L_j2:
    v_and_b32 v8, 8, v14
    s_barrier
    ds_read_b64 v[4:5], v8 offset:1056
    s_waitcnt lgkmcnt(0)
    v_mul_f32 v24, s64, v5
    v_mul_f32 v26, s65, v5
    v_mul_f32 v28, s66, v5
    v_mul_f32 v30, s67, v5
    v_fma_f32 v25, -v4, v24, s68
    v_fma_f32 v27, -v4, v26, s69
    v_fma_f32 v29, -v4, v28, s70
    v_fma_f32 v31, -v4, v30, s71
    global_load_dwordx4 v[160:163], v13, s[8:9] offset:1024 nt
    global_load_dwordx4 v[164:167], v13, s[8:9] offset:2048 nt
    global_load_dwordx4 v[168:171], v13, s[8:9] offset:3072 nt
    s_barrier
    v_lshlrev_b32 v16, 16, v108
    v_and_b32 v17, s31, v108
    v_lshlrev_b32 v18, 16, v109
    v_and_b32 v19, s31, v109
    v_lshlrev_b32 v20, 16, v110
    v_and_b32 v21, s31, v110
    v_lshlrev_b32 v22, 16, v111
    v_and_b32 v23, s31, v111
    v_pk_fma_f32 v[16:17], v[16:17], v[24:25], v[24:25] op_sel:[0,0,1] op_sel_hi:[1,0,1]
    v_pk_fma_f32 v[18:19], v[18:19], v[24:25], v[24:25] op_sel:[0,0,1] op_sel_hi:[1,0,1]
    v_pk_fma_f32 v[20:21], v[20:21], v[24:25], v[24:25] op_sel:[0,0,1] op_sel_hi:[1,0,1]
    v_pk_fma_f32 v[22:23], v[22:23], v[24:25], v[24:25] op_sel:[0,0,1] op_sel_hi:[1,0,1]
    v_cvt_pk_bf16_f32 v108, v16, v17
    v_cvt_pk_bf16_f32 v109, v18, v19
    v_cvt_pk_bf16_f32 v110, v20, v21
    v_cvt_pk_bf16_f32 v111, v22, v23
    global_store_dwordx4 v12, v[108:111], s[14:15] offset:-4096 sc1
    v_lshlrev_b32 v16, 16, v124
    v_and_b32 v17, s31, v124
    v_lshlrev_b32 v18, 16, v125
    v_and_b32 v19, s31, v125
    v_lshlrev_b32 v20, 16, v126
    v_and_b32 v21, s31, v126
    v_lshlrev_b32 v22, 16, v127
    v_and_b32 v23, s31, v127
    v_pk_fma_f32 v[16:17], v[16:17], v[28:29], v[28:29] op_sel:[0,0,1] op_sel_hi:[1,0,1]
    v_pk_fma_f32 v[18:19], v[18:19], v[28:29], v[28:29] op_sel:[0,0,1] op_sel_hi:[1,0,1]
    v_pk_fma_f32 v[20:21], v[20:21], v[28:29], v[28:29] op_sel:[0,0,1] op_sel_hi:[1,0,1]
    v_pk_fma_f32 v[22:23], v[22:23], v[28:29], v[28:29] op_sel:[0,0,1] op_sel_hi:[1,0,1]
    v_cvt_pk_bf16_f32 v124, v16, v17
    v_cvt_pk_bf16_f32 v125, v18, v19
    v_cvt_pk_bf16_f32 v126, v20, v21
    v_cvt_pk_bf16_f32 v127, v22, v23
    global_store_dwordx4 v12, v[124:127], s[14:15] offset:0 sc1
    v_lshlrev_b32 v16, 16, v112
    v_and_b32 v17, s31, v112
    v_lshlrev_b32 v18, 16, v113
    v_and_b32 v19, s31, v113
    v_lshlrev_b32 v20, 16, v114
    v_and_b32 v21, s31, v114
    v_lshlrev_b32 v22, 16, v115
    v_and_b32 v23, s31, v115
    v_pk_fma_f32 v[16:17], v[16:17], v[24:25], v[24:25] op_sel:[0,0,1] op_sel_hi:[1,0,1]
    v_pk_fma_f32 v[18:19], v[18:19], v[24:25], v[24:25] op_sel:[0,0,1] op_sel_hi:[1,0,1]
    v_pk_fma_f32 v[20:21], v[20:21], v[24:25], v[24:25] op_sel:[0,0,1] op_sel_hi:[1,0,1]
    v_pk_fma_f32 v[22:23], v[22:23], v[24:25], v[24:25] op_sel:[0,0,1] op_sel_hi:[1,0,1]
    v_cvt_pk_bf16_f32 v112, v16, v17
    v_cvt_pk_bf16_f32 v113, v18, v19
    v_cvt_pk_bf16_f32 v114, v20, v21
    v_cvt_pk_bf16_f32 v115, v22, v23
    global_store_dwordx4 v12, v[112:115], s[14:15] offset:-3072 sc1
    v_mov_b32 v4, 0
    v_mov_b32 v5, 0
    s_waitcnt vmcnt(17)
    v_dot2c_f32_bf16 v4, s30, v140
    v_dot2c_f32_bf16 v5, v140, v140
    v_dot2c_f32_bf16 v4, s30, v141
    v_dot2c_f32_bf16 v5, v141, v141
    v_dot2c_f32_bf16 v4, s30, v142
    v_dot2c_f32_bf16 v5, v142, v142
    v_dot2c_f32_bf16 v4, s30, v143
    v_dot2c_f32_bf16 v5, v143, v143
    s_waitcnt vmcnt(15)
    v_dot2c_f32_bf16 v4, s30, v144
    v_dot2c_f32_bf16 v5, v144, v144
    v_dot2c_f32_bf16 v4, s30, v145
    v_dot2c_f32_bf16 v5, v145, v145
    v_dot2c_f32_bf16 v4, s30, v146
    v_dot2c_f32_bf16 v5, v146, v146
    v_dot2c_f32_bf16 v4, s30, v147
    v_dot2c_f32_bf16 v5, v147, v147
    s_waitcnt vmcnt(13)
    v_dot2c_f32_bf16 v4, s30, v148
    v_dot2c_f32_bf16 v5, v148, v148
    v_dot2c_f32_bf16 v4, s30, v149
    v_dot2c_f32_bf16 v5, v149, v149
    v_dot2c_f32_bf16 v4, s30, v150
    v_dot2c_f32_bf16 v5, v150, v150
    v_dot2c_f32_bf16 v4, s30, v151
    v_dot2c_f32_bf16 v5, v151, v151
    s_waitcnt vmcnt(11)
    v_dot2c_f32_bf16 v4, s30, v152
    v_dot2c_f32_bf16 v5, v152, v152
    v_dot2c_f32_bf16 v4, s30, v153
    v_dot2c_f32_bf16 v5, v153, v153
    v_dot2c_f32_bf16 v4, s30, v154
    v_dot2c_f32_bf16 v5, v154, v154
    v_dot2c_f32_bf16 v4, s30, v155
    v_dot2c_f32_bf16 v5, v155, v155
    s_waitcnt vmcnt(10)
    v_dot2c_f32_bf16 v4, s30, v156
    v_dot2c_f32_bf16 v5, v156, v156
    v_dot2c_f32_bf16 v4, s30, v157
    v_dot2c_f32_bf16 v5, v157, v157
    v_dot2c_f32_bf16 v4, s30, v158
    v_dot2c_f32_bf16 v5, v158, v158
    v_dot2c_f32_bf16 v4, s30, v159
    v_dot2c_f32_bf16 v5, v159, v159
    s_waitcnt vmcnt(5)
    v_dot2c_f32_bf16 v4, s30, v160
    v_dot2c_f32_bf16 v5, v160, v160
    v_dot2c_f32_bf16 v4, s30, v161
    v_dot2c_f32_bf16 v5, v161, v161
    v_dot2c_f32_bf16 v4, s30, v162
    v_dot2c_f32_bf16 v5, v162, v162
    v_dot2c_f32_bf16 v4, s30, v163
    v_dot2c_f32_bf16 v5, v163, v163
    s_waitcnt vmcnt(4)
    v_dot2c_f32_bf16 v4, s30, v164
    v_dot2c_f32_bf16 v5, v164, v164
    v_dot2c_f32_bf16 v4, s30, v165
    v_dot2c_f32_bf16 v5, v165, v165
    v_dot2c_f32_bf16 v4, s30, v166
    v_dot2c_f32_bf16 v5, v166, v166
    v_dot2c_f32_bf16 v4, s30, v167
    v_dot2c_f32_bf16 v5, v167, v167
    s_waitcnt vmcnt(3)
    v_dot2c_f32_bf16 v4, s30, v168
    v_dot2c_f32_bf16 v5, v168, v168
    v_dot2c_f32_bf16 v4, s30, v169
    v_dot2c_f32_bf16 v5, v169, v169
    v_dot2c_f32_bf16 v4, s30, v170
    v_dot2c_f32_bf16 v5, v170, v170
    v_dot2c_f32_bf16 v4, s30, v171
    v_dot2c_f32_bf16 v5, v171, v171
    s_nop 1
    v_mul_f32 v10, 0xbc800000, v4
    v_add_f32_dpp v8, v4, v4 quad_perm:[1,0,3,2] row_mask:0xf bank_mask:0xf
    v_fmac_f32 v5, v10, v4
    s_nop 0
    v_add_f32_dpp v8, v8, v8 quad_perm:[2,3,0,1] row_mask:0xf bank_mask:0xf
    s_nop 1
    v_add_f32_dpp v8, v8, v8 row_half_mirror row_mask:0xf bank_mask:0xf
    s_nop 1
    v_add_f32_dpp v8, v8, v8 row_mirror row_mask:0xf bank_mask:0xf
    v_fmac_f32 v4, 0xbd800000, v8
    v_mul_f32 v10, 0x3c800000, v4
    v_fmac_f32 v5, v10, v4
    v_mov_b32 v4, v8
    s_nop 0
    v_add_f32_dpp v5, v5, v5 quad_perm:[1,0,3,2] row_mask:0xf bank_mask:0xf
    s_nop 1
    v_add_f32_dpp v5, v5, v5 quad_perm:[2,3,0,1] row_mask:0xf bank_mask:0xf
    s_nop 1
    v_add_f32_dpp v5, v5, v5 row_half_mirror row_mask:0xf bank_mask:0xf
    s_nop 1
    v_add_f32_dpp v5, v5, v5 row_mirror row_mask:0xf bank_mask:0xf
    ds_write_b64 v14, v[4:5] offset:768
    s_waitcnt lgkmcnt(0)
    s_barrier
    s_cmp_lg_u32 s3, 0
    s_cbranch_scc1 L_np2
    ds_read_b128 v[4:7], v3 offset:768
    s_waitcnt lgkmcnt(0)
    s_nop 0
    v_add_f32_dpp v8, v4, v4 quad_perm:[1,0,3,2] row_mask:0xf bank_mask:0xf
    v_add_f32_dpp v9, v6, v6 quad_perm:[1,0,3,2] row_mask:0xf bank_mask:0xf
    s_nop 0
    v_add_f32_dpp v8, v8, v8 quad_perm:[2,3,0,1] row_mask:0xf bank_mask:0xf
    v_add_f32_dpp v9, v9, v9 quad_perm:[2,3,0,1] row_mask:0xf bank_mask:0xf
    s_nop 0
    v_add_f32_dpp v8, v8, v8 row_half_mirror row_mask:0xf bank_mask:0xf
    v_add_f32_dpp v9, v9, v9 row_half_mirror row_mask:0xf bank_mask:0xf
    s_nop 0
    v_add_f32_dpp v8, v8, v8 row_mirror row_mask:0xf bank_mask:0xf
    v_add_f32_dpp v9, v9, v9 row_mirror row_mask:0xf bank_mask:0xf
    v_fmac_f32 v4, 0xbd800000, v8
    v_fmac_f32 v6, 0xbd800000, v9
    v_mul_f32 v10, 0x3a800000, v4
    v_mul_f32 v11, 0x3a800000, v6
    v_fmac_f32 v5, v10, v4
    v_fmac_f32 v7, v11, v6
    v_mov_b32 v4, v8
    v_mov_b32 v6, v9
    v_add_f32_dpp v5, v5, v5 quad_perm:[1,0,3,2] row_mask:0xf bank_mask:0xf
    v_add_f32_dpp v7, v7, v7 quad_perm:[1,0,3,2] row_mask:0xf bank_mask:0xf
    s_nop 0
    v_add_f32_dpp v5, v5, v5 quad_perm:[2,3,0,1] row_mask:0xf bank_mask:0xf
    v_add_f32_dpp v7, v7, v7 quad_perm:[2,3,0,1] row_mask:0xf bank_mask:0xf
    s_nop 0
    v_add_f32_dpp v5, v5, v5 row_half_mirror row_mask:0xf bank_mask:0xf
    v_add_f32_dpp v7, v7, v7 row_half_mirror row_mask:0xf bank_mask:0xf
    s_nop 0
    v_add_f32_dpp v5, v5, v5 row_mirror row_mask:0xf bank_mask:0xf
    v_add_f32_dpp v7, v7, v7 row_mirror row_mask:0xf bank_mask:0xf
    v_cndmask_b32 v32, v4, v6, vcc
    v_cndmask_b32 v34, v5, v7, vcc
    s_mov_b64 exec, 0xc0
    global_store_dwordx4 v40, v[32:35], s[18:19] sc1
    s_mov_b64 exec, -1
    v_mov_b32 v38, v32
    v_mov_b32 v39, v34
L_np2:
    v_lshlrev_b32 v16, 16, v128
    v_and_b32 v17, s31, v128
    v_lshlrev_b32 v18, 16, v129
    v_and_b32 v19, s31, v129
    v_lshlrev_b32 v20, 16, v130
    v_and_b32 v21, s31, v130
    v_lshlrev_b32 v22, 16, v131
    v_and_b32 v23, s31, v131
    v_pk_fma_f32 v[16:17], v[16:17], v[28:29], v[28:29] op_sel:[0,0,1] op_sel_hi:[1,0,1]
    v_pk_fma_f32 v[18:19], v[18:19], v[28:29], v[28:29] op_sel:[0,0,1] op_sel_hi:[1,0,1]
    v_pk_fma_f32 v[20:21], v[20:21], v[28:29], v[28:29] op_sel:[0,0,1] op_sel_hi:[1,0,1]
    v_pk_fma_f32 v[22:23], v[22:23], v[28:29], v[28:29] op_sel:[0,0,1] op_sel_hi:[1,0,1]
    v_cvt_pk_bf16_f32 v128, v16, v17
    v_cvt_pk_bf16_f32 v129, v18, v19
    v_cvt_pk_bf16_f32 v130, v20, v21
    v_cvt_pk_bf16_f32 v131, v22, v23
    global_store_dwordx4 v12, v[128:131], s[14:15] offset:1024 sc1
    v_lshlrev_b32 v16, 16, v116
    v_and_b32 v17, s31, v116
    v_lshlrev_b32 v18, 16, v117
    v_and_b32 v19, s31, v117
    v_lshlrev_b32 v20, 16, v118
    v_and_b32 v21, s31, v118
    v_lshlrev_b32 v22, 16, v119
    v_and_b32 v23, s31, v119
    v_pk_fma_f32 v[16:17], v[16:17], v[26:27], v[26:27] op_sel:[0,0,1] op_sel_hi:[1,0,1]
    v_pk_fma_f32 v[18:19], v[18:19], v[26:27], v[26:27] op_sel:[0,0,1] op_sel_hi:[1,0,1]
    v_pk_fma_f32 v[20:21], v[20:21], v[26:27], v[26:27] op_sel:[0,0,1] op_sel_hi:[1,0,1]
    v_pk_fma_f32 v[22:23], v[22:23], v[26:27], v[26:27] op_sel:[0,0,1] op_sel_hi:[1,0,1]
    v_cvt_pk_bf16_f32 v116, v16, v17
    v_cvt_pk_bf16_f32 v117, v18, v19
    v_cvt_pk_bf16_f32 v118, v20, v21
    v_cvt_pk_bf16_f32 v119, v22, v23
    global_store_dwordx4 v12, v[116:119], s[14:15] offset:-2048 sc1
    s_cmp_lg_u32 s3, 0
    s_cbranch_scc1 L_ne3
    s_load_dwordx8 s[48:55], s[18:19], s47 offset:96 glc
L_ne3:
    v_lshlrev_b32 v16, 16, v132
    v_and_b32 v17, s31, v132
    v_lshlrev_b32 v18, 16, v133
    v_and_b32 v19, s31, v133
    v_lshlrev_b32 v20, 16, v134
    v_and_b32 v21, s31, v134
    v_lshlrev_b32 v22, 16, v135
    v_and_b32 v23, s31, v135
    v_pk_fma_f32 v[16:17], v[16:17], v[30:31], v[30:31] op_sel:[0,0,1] op_sel_hi:[1,0,1]
    v_pk_fma_f32 v[18:19], v[18:19], v[30:31], v[30:31] op_sel:[0,0,1] op_sel_hi:[1,0,1]
    v_pk_fma_f32 v[20:21], v[20:21], v[30:31], v[30:31] op_sel:[0,0,1] op_sel_hi:[1,0,1]
    v_pk_fma_f32 v[22:23], v[22:23], v[30:31], v[30:31] op_sel:[0,0,1] op_sel_hi:[1,0,1]
    v_cvt_pk_bf16_f32 v132, v16, v17
    v_cvt_pk_bf16_f32 v133, v18, v19
    v_cvt_pk_bf16_f32 v134, v20, v21
    v_cvt_pk_bf16_f32 v135, v22, v23
    global_store_dwordx4 v12, v[132:135], s[14:15] offset:2048 sc1
    v_lshlrev_b32 v16, 16, v120
    v_and_b32 v17, s31, v120
    v_lshlrev_b32 v18, 16, v121
    v_and_b32 v19, s31, v121
    v_lshlrev_b32 v20, 16, v122
    v_and_b32 v21, s31, v122
    v_lshlrev_b32 v22, 16, v123
    v_and_b32 v23, s31, v123
    v_pk_fma_f32 v[16:17], v[16:17], v[26:27], v[26:27] op_sel:[0,0,1] op_sel_hi:[1,0,1]
    v_pk_fma_f32 v[18:19], v[18:19], v[26:27], v[26:27] op_sel:[0,0,1] op_sel_hi:[1,0,1]
    v_pk_fma_f32 v[20:21], v[20:21], v[26:27], v[26:27] op_sel:[0,0,1] op_sel_hi:[1,0,1]
    v_pk_fma_f32 v[22:23], v[22:23], v[26:27], v[26:27] op_sel:[0,0,1] op_sel_hi:[1,0,1]
    v_cvt_pk_bf16_f32 v120, v16, v17
    v_cvt_pk_bf16_f32 v121, v18, v19
    v_cvt_pk_bf16_f32 v122, v20, v21
    v_cvt_pk_bf16_f32 v123, v22, v23
    global_store_dwordx4 v12, v[120:123], s[14:15] offset:-1024 sc1
    v_lshlrev_b32 v16, 16, v136
    v_and_b32 v17, s31, v136
    v_lshlrev_b32 v18, 16, v137
    v_and_b32 v19, s31, v137
    v_lshlrev_b32 v20, 16, v138
    v_and_b32 v21, s31, v138
    v_lshlrev_b32 v22, 16, v139
    v_and_b32 v23, s31, v139
    v_pk_fma_f32 v[16:17], v[16:17], v[30:31], v[30:31] op_sel:[0,0,1] op_sel_hi:[1,0,1]
    v_pk_fma_f32 v[18:19], v[18:19], v[30:31], v[30:31] op_sel:[0,0,1] op_sel_hi:[1,0,1]
    v_pk_fma_f32 v[20:21], v[20:21], v[30:31], v[30:31] op_sel:[0,0,1] op_sel_hi:[1,0,1]
    v_pk_fma_f32 v[22:23], v[22:23], v[30:31], v[30:31] op_sel:[0,0,1] op_sel_hi:[1,0,1]
    v_cvt_pk_bf16_f32 v136, v16, v17
    v_cvt_pk_bf16_f32 v137, v18, v19
    v_cvt_pk_bf16_f32 v138, v20, v21
    v_cvt_pk_bf16_f32 v139, v22, v23
    global_store_dwordx4 v12, v[136:139], s[14:15] offset:3072 sc1
    s_cmp_lg_u32 s3, 0
    s_cbranch_scc1 L_j3
    v_readlane_b32 s56, v33, 14
    v_readlane_b32 s57, v35, 14
    v_readlane_b32 s58, v33, 15
    v_readlane_b32 s59, v35, 15
    s_movk_i32 s46, 160
L_pp3:
    s_waitcnt lgkmcnt(0)
    s_xor_b32 s5, s49, s56
    s_xor_b32 s28, s51, s57
    s_or_b32 s5, s5, s28
    s_xor_b32 s28, s53, s58
    s_or_b32 s5, s5, s28
    s_xor_b32 s28, s55, s59
    s_or_b32 s5, s5, s28
    s_cbranch_scc1 L_pm3
    v_mov_b32 v6, s48
    v_mov_b32 v7, s50
    v_writelane_b32 v6, s52, 1
    v_writelane_b32 v7, s54, 1
L_mg3:
    v_mov_b32 v4, v38
    v_mov_b32 v5, v39
    v_sub_f32 v8, v4, v6
    v_add_f32 v4, v4, v6
    v_add_f32 v5, v5, v7
    v_mul_f32 v9, 0x38000000, v8
    v_mul_f32 v6, 0x38000000, v4
    v_fmac_f32 v5, v9, v8
    v_cvt_pk_bf16_f32 v4, v6, v6
    v_lshlrev_b32 v4, 16, v4
    v_sub_f32 v6, v6, v4
    v_mul_f32 v6, v6, v6
    v_fmac_f32 v6, 0x38000000, v5
    v_max_f32 v5, 0, v6
    v_cvt_pk_bf16_f32 v5, v5, v5
    v_lshlrev_b32 v5, 16, v5
    v_add_f32 v5, 0x3727c5ac, v5
    v_cvt_pk_bf16_f32 v5, v5, v5
    v_lshlrev_b32 v5, 16, v5
    v_sqrt_f32 v5, v5
    s_nop 0
    v_cvt_pk_bf16_f32 v5, v5, v5
    v_lshlrev_b32 v5, 16, v5
    v_rcp_f32 v5, v5
    s_nop 0
    v_lshlrev_b32 v8, 3, v0
    s_mov_b64 exec, 3
    ds_write_b64 v8, v[4:5] offset:1072
    s_mov_b64 exec, -1
    s_waitcnt lgkmcnt(0)
L_j3:
    v_and_b32 v8, 8, v14
    s_barrier
    ds_read_b64 v[4:5], v8 offset:1072
    s_waitcnt lgkmcnt(0)
    v_mul_f32 v24, s64, v5
    v_mul_f32 v26, s65, v5
    v_mul_f32 v28, s66, v5
    v_mul_f32 v30, s67, v5
    v_fma_f32 v25, -v4, v24, s68
    v_fma_f32 v27, -v4, v26, s69
    v_fma_f32 v29, -v4, v28, s70
    v_fma_f32 v31, -v4, v30, s71
    v_lshlrev_b32 v16, 16, v140
    v_and_b32 v17, s31, v140
    v_lshlrev_b32 v18, 16, v141
    v_and_b32 v19, s31, v141
    v_lshlrev_b32 v20, 16, v142
    v_and_b32 v21, s31, v142
    v_lshlrev_b32 v22, 16, v143
    v_and_b32 v23, s31, v143
    v_pk_fma_f32 v[16:17], v[16:17], v[24:25], v[24:25] op_sel:[0,0,1] op_sel_hi:[1,0,1]
    v_pk_fma_f32 v[18:19], v[18:19], v[24:25], v[24:25] op_sel:[0,0,1] op_sel_hi:[1,0,1]
    v_pk_fma_f32 v[20:21], v[20:21], v[24:25], v[24:25] op_sel:[0,0,1] op_sel_hi:[1,0,1]
    v_pk_fma_f32 v[22:23], v[22:23], v[24:25], v[24:25] op_sel:[0,0,1] op_sel_hi:[1,0,1]
    v_cvt_pk_bf16_f32 v140, v16, v17
    v_cvt_pk_bf16_f32 v141, v18, v19
    v_cvt_pk_bf16_f32 v142, v20, v21
    v_cvt_pk_bf16_f32 v143, v22, v23
    global_store_dwordx4 v13, v[140:143], s[14:15] offset:-4096 sc1
    v_lshlrev_b32 v16, 16, v156
    v_and_b32 v17, s31, v156
    v_lshlrev_b32 v18, 16, v157
    v_and_b32 v19, s31, v157
    v_lshlrev_b32 v20, 16, v158
    v_and_b32 v21, s31, v158
    v_lshlrev_b32 v22, 16, v159
    v_and_b32 v23, s31, v159
    v_pk_fma_f32 v[16:17], v[16:17], v[28:29], v[28:29] op_sel:[0,0,1] op_sel_hi:[1,0,1]
    v_pk_fma_f32 v[18:19], v[18:19], v[28:29], v[28:29] op_sel:[0,0,1] op_sel_hi:[1,0,1]
    v_pk_fma_f32 v[20:21], v[20:21], v[28:29], v[28:29] op_sel:[0,0,1] op_sel_hi:[1,0,1]
    v_pk_fma_f32 v[22:23], v[22:23], v[28:29], v[28:29] op_sel:[0,0,1] op_sel_hi:[1,0,1]
    v_cvt_pk_bf16_f32 v156, v16, v17
    v_cvt_pk_bf16_f32 v157, v18, v19
    v_cvt_pk_bf16_f32 v158, v20, v21
    v_cvt_pk_bf16_f32 v159, v22, v23
    global_store_dwordx4 v13, v[156:159], s[14:15] offset:0 sc1
    v_lshlrev_b32 v16, 16, v144
    v_and_b32 v17, s31, v144
    v_lshlrev_b32 v18, 16, v145
    v_and_b32 v19, s31, v145
    v_lshlrev_b32 v20, 16, v146
    v_and_b32 v21, s31, v146
    v_lshlrev_b32 v22, 16, v147
    v_and_b32 v23, s31, v147
    v_pk_fma_f32 v[16:17], v[16:17], v[24:25], v[24:25] op_sel:[0,0,1] op_sel_hi:[1,0,1]
    v_pk_fma_f32 v[18:19], v[18:19], v[24:25], v[24:25] op_sel:[0,0,1] op_sel_hi:[1,0,1]
    v_pk_fma_f32 v[20:21], v[20:21], v[24:25], v[24:25] op_sel:[0,0,1] op_sel_hi:[1,0,1]
    v_pk_fma_f32 v[22:23], v[22:23], v[24:25], v[24:25] op_sel:[0,0,1] op_sel_hi:[1,0,1]
    v_cvt_pk_bf16_f32 v144, v16, v17
    v_cvt_pk_bf16_f32 v145, v18, v19
    v_cvt_pk_bf16_f32 v146, v20, v21
    v_cvt_pk_bf16_f32 v147, v22, v23
    global_store_dwordx4 v13, v[144:147], s[14:15] offset:-3072 sc1
    v_lshlrev_b32 v16, 16, v160
    v_and_b32 v17, s31, v160
    v_lshlrev_b32 v18, 16, v161
    v_and_b32 v19, s31, v161
    v_lshlrev_b32 v20, 16, v162
    v_and_b32 v21, s31, v162
    v_lshlrev_b32 v22, 16, v163
    v_and_b32 v23, s31, v163
    v_pk_fma_f32 v[16:17], v[16:17], v[28:29], v[28:29] op_sel:[0,0,1] op_sel_hi:[1,0,1]
    v_pk_fma_f32 v[18:19], v[18:19], v[28:29], v[28:29] op_sel:[0,0,1] op_sel_hi:[1,0,1]
    v_pk_fma_f32 v[20:21], v[20:21], v[28:29], v[28:29] op_sel:[0,0,1] op_sel_hi:[1,0,1]
    v_pk_fma_f32 v[22:23], v[22:23], v[28:29], v[28:29] op_sel:[0,0,1] op_sel_hi:[1,0,1]
    v_cvt_pk_bf16_f32 v160, v16, v17
    v_cvt_pk_bf16_f32 v161, v18, v19
    v_cvt_pk_bf16_f32 v162, v20, v21
    v_cvt_pk_bf16_f32 v163, v22, v23
    global_store_dwordx4 v13, v[160:163], s[14:15] offset:1024 sc1
    v_lshlrev_b32 v16, 16, v148
    v_and_b32 v17, s31, v148
    v_lshlrev_b32 v18, 16, v149
    v_and_b32 v19, s31, v149
    v_lshlrev_b32 v20, 16, v150
    v_and_b32 v21, s31, v150
    v_lshlrev_b32 v22, 16, v151
    v_and_b32 v23, s31, v151
    v_pk_fma_f32 v[16:17], v[16:17], v[26:27], v[26:27] op_sel:[0,0,1] op_sel_hi:[1,0,1]
    v_pk_fma_f32 v[18:19], v[18:19], v[26:27], v[26:27] op_sel:[0,0,1] op_sel_hi:[1,0,1]
    v_pk_fma_f32 v[20:21], v[20:21], v[26:27], v[26:27] op_sel:[0,0,1] op_sel_hi:[1,0,1]
    v_pk_fma_f32 v[22:23], v[22:23], v[26:27], v[26:27] op_sel:[0,0,1] op_sel_hi:[1,0,1]
    v_cvt_pk_bf16_f32 v148, v16, v17
    v_cvt_pk_bf16_f32 v149, v18, v19
    v_cvt_pk_bf16_f32 v150, v20, v21
    v_cvt_pk_bf16_f32 v151, v22, v23
    global_store_dwordx4 v13, v[148:151], s[14:15] offset:-2048 sc1
    v_lshlrev_b32 v16, 16, v164
    v_and_b32 v17, s31, v164
    v_lshlrev_b32 v18, 16, v165
    v_and_b32 v19, s31, v165
    v_lshlrev_b32 v20, 16, v166
    v_and_b32 v21, s31, v166
    v_lshlrev_b32 v22, 16, v167
    v_and_b32 v23, s31, v167
    v_pk_fma_f32 v[16:17], v[16:17], v[30:31], v[30:31] op_sel:[0,0,1] op_sel_hi:[1,0,1]
    v_pk_fma_f32 v[18:19], v[18:19], v[30:31], v[30:31] op_sel:[0,0,1] op_sel_hi:[1,0,1]
    v_pk_fma_f32 v[20:21], v[20:21], v[30:31], v[30:31] op_sel:[0,0,1] op_sel_hi:[1,0,1]
    v_pk_fma_f32 v[22:23], v[22:23], v[30:31], v[30:31] op_sel:[0,0,1] op_sel_hi:[1,0,1]
    v_cvt_pk_bf16_f32 v164, v16, v17
    v_cvt_pk_bf16_f32 v165, v18, v19
    v_cvt_pk_bf16_f32 v166, v20, v21
    v_cvt_pk_bf16_f32 v167, v22, v23
    global_store_dwordx4 v13, v[164:167], s[14:15] offset:2048 sc1
    v_lshlrev_b32 v16, 16, v152
    v_and_b32 v17, s31, v152
    v_lshlrev_b32 v18, 16, v153
    v_and_b32 v19, s31, v153
    v_lshlrev_b32 v20, 16, v154
    v_and_b32 v21, s31, v154
    v_lshlrev_b32 v22, 16, v155
    v_and_b32 v23, s31, v155
    v_pk_fma_f32 v[16:17], v[16:17], v[26:27], v[26:27] op_sel:[0,0,1] op_sel_hi:[1,0,1]
    v_pk_fma_f32 v[18:19], v[18:19], v[26:27], v[26:27] op_sel:[0,0,1] op_sel_hi:[1,0,1]
    v_pk_fma_f32 v[20:21], v[20:21], v[26:27], v[26:27] op_sel:[0,0,1] op_sel_hi:[1,0,1]
    v_pk_fma_f32 v[22:23], v[22:23], v[26:27], v[26:27] op_sel:[0,0,1] op_sel_hi:[1,0,1]
    v_cvt_pk_bf16_f32 v152, v16, v17
    v_cvt_pk_bf16_f32 v153, v18, v19
    v_cvt_pk_bf16_f32 v154, v20, v21
    v_cvt_pk_bf16_f32 v155, v22, v23
    global_store_dwordx4 v13, v[152:155], s[14:15] offset:-1024 sc1
    v_lshlrev_b32 v16, 16, v168
    v_and_b32 v17, s31, v168
    v_lshlrev_b32 v18, 16, v169
    v_and_b32 v19, s31, v169
    v_lshlrev_b32 v20, 16, v170
    v_and_b32 v21, s31, v170
    v_lshlrev_b32 v22, 16, v171
    v_and_b32 v23, s31, v171
    v_pk_fma_f32 v[16:17], v[16:17], v[30:31], v[30:31] op_sel:[0,0,1] op_sel_hi:[1,0,1]
    v_pk_fma_f32 v[18:19], v[18:19], v[30:31], v[30:31] op_sel:[0,0,1] op_sel_hi:[1,0,1]
    v_pk_fma_f32 v[20:21], v[20:21], v[30:31], v[30:31] op_sel:[0,0,1] op_sel_hi:[1,0,1]
    v_pk_fma_f32 v[22:23], v[22:23], v[30:31], v[30:31] op_sel:[0,0,1] op_sel_hi:[1,0,1]
    v_cvt_pk_bf16_f32 v168, v16, v17
    v_cvt_pk_bf16_f32 v169, v18, v19
    v_cvt_pk_bf16_f32 v170, v20, v21
    v_cvt_pk_bf16_f32 v171, v22, v23
    global_store_dwordx4 v13, v[168:171], s[14:15] offset:3072 sc1
L_end:
    s_endpgm
L_pm2:
    s_load_dwordx8 s[48:55], s[18:19], s47 offset:64 glc
    s_sleep 2
    s_sub_u32 s46, s46, 1
    s_cmp_lg_u32 s46, 0
    s_cbranch_scc1 L_pp2
    s_branch L_alone2
L_pm3:
    s_load_dwordx8 s[48:55], s[18:19], s47 offset:96 glc
    s_sleep 2
    s_sub_u32 s46, s46, 1
    s_cmp_lg_u32 s46, 0
    s_cbranch_scc1 L_pp3
    s_branch L_alone3
L_hot_end:
L_alone2:
    s_waitcnt lgkmcnt(0)
    v_xor_b32 v36, 0x2000, v12
    v_add_u32 v37, 0x40000, v36
    v_mov_b32 v4, 0
    v_mov_b32 v5, 0
    v_mov_b32 v6, 0
    v_mov_b32 v7, 0
L_so2:
    global_load_dwordx4 v[16:19], v36, s[8:9] offset:-4096
    global_load_dwordx4 v[20:23], v37, s[8:9] offset:-4096
    s_add_u32 s46, s46, 1
    s_and_b32 s5, s46, 7
    s_cselect_b32 s5, 0, 0x2000
    s_add_u32 s5, s5, 0x400
    s_waitcnt vmcnt(0)
    v_add_u32 v36, s5, v36
    v_add_u32 v37, s5, v37
    v_dot2c_f32_bf16 v4, s30, v16
    v_dot2c_f32_bf16 v5, v16, v16
    v_dot2c_f32_bf16 v6, s30, v20
    v_dot2c_f32_bf16 v7, v20, v20
    v_dot2c_f32_bf16 v4, s30, v17
    v_dot2c_f32_bf16 v5, v17, v17
    v_dot2c_f32_bf16 v6, s30, v21
    v_dot2c_f32_bf16 v7, v21, v21
    v_dot2c_f32_bf16 v4, s30, v18
    v_dot2c_f32_bf16 v5, v18, v18
    v_dot2c_f32_bf16 v6, s30, v22
    v_dot2c_f32_bf16 v7, v22, v22
    v_dot2c_f32_bf16 v4, s30, v19
    v_dot2c_f32_bf16 v5, v19, v19
    v_dot2c_f32_bf16 v6, s30, v23
    v_dot2c_f32_bf16 v7, v23, v23
    s_cmp_lt_u32 s46, 32
    s_cbranch_scc1 L_so2
    s_nop 1
    v_mul_f32 v10, 0xbb800000, v4
    v_mul_f32 v11, 0xbb800000, v6
    v_fmac_f32 v5, v10, v4
    v_fmac_f32 v7, v11, v6
    s_nop 0
    v_add_f32_dpp v8, v4, v4 quad_perm:[1,0,3,2] row_mask:0xf bank_mask:0xf
    v_add_f32_dpp v9, v6, v6 quad_perm:[1,0,3,2] row_mask:0xf bank_mask:0xf
    s_nop 0
    v_add_f32_dpp v8, v8, v8 quad_perm:[2,3,0,1] row_mask:0xf bank_mask:0xf
    v_add_f32_dpp v9, v9, v9 quad_perm:[2,3,0,1] row_mask:0xf bank_mask:0xf
    s_nop 0
    v_add_f32_dpp v8, v8, v8 row_half_mirror row_mask:0xf bank_mask:0xf
    v_add_f32_dpp v9, v9, v9 row_half_mirror row_mask:0xf bank_mask:0xf
    s_nop 0
    v_add_f32_dpp v8, v8, v8 row_mirror row_mask:0xf bank_mask:0xf
    v_add_f32_dpp v9, v9, v9 row_mirror row_mask:0xf bank_mask:0xf
    v_fmac_f32 v4, 0xbd800000, v8
    v_fmac_f32 v6, 0xbd800000, v9
    v_mul_f32 v10, 0x3b800000, v4
    v_mul_f32 v11, 0x3b800000, v6
    v_fmac_f32 v5, v10, v4
    v_fmac_f32 v7, v11, v6
    v_mov_b32 v4, v8
    v_mov_b32 v6, v9
    v_add_f32_dpp v5, v5, v5 quad_perm:[1,0,3,2] row_mask:0xf bank_mask:0xf
    v_add_f32_dpp v7, v7, v7 quad_perm:[1,0,3,2] row_mask:0xf bank_mask:0xf
    s_nop 0
    v_add_f32_dpp v5, v5, v5 quad_perm:[2,3,0,1] row_mask:0xf bank_mask:0xf
    v_add_f32_dpp v7, v7, v7 quad_perm:[2,3,0,1] row_mask:0xf bank_mask:0xf
    s_nop 0
    v_add_f32_dpp v5, v5, v5 row_half_mirror row_mask:0xf bank_mask:0xf
    v_add_f32_dpp v7, v7, v7 row_half_mirror row_mask:0xf bank_mask:0xf
    s_nop 0
    v_add_f32_dpp v5, v5, v5 row_mirror row_mask:0xf bank_mask:0xf
    v_add_f32_dpp v7, v7, v7 row_mirror row_mask:0xf bank_mask:0xf
    v_mov_b32 v8, v4
    v_mov_b32 v9, v5
    v_mov_b32 v10, v6
    v_mov_b32 v11, v7
    s_nop 1
    v_permlane16_swap_b32 v4, v8
    v_permlane16_swap_b32 v5, v9
    v_permlane16_swap_b32 v6, v10
    v_permlane16_swap_b32 v7, v11
    s_nop 1
    v_add_f32 v5, v5, v9
    v_add_f32 v7, v7, v11
    v_sub_f32 v9, v4, v8
    v_sub_f32 v11, v6, v10
    v_add_f32 v4, v4, v8
    v_add_f32 v6, v6, v10
    v_mul_f32 v8, 0x39000000, v9
    v_mul_f32 v10, 0x39000000, v11
    v_fmac_f32 v5, v8, v9
    v_fmac_f32 v7, v10, v11
    v_mov_b32 v8, v4
    v_mov_b32 v9, v5
    v_mov_b32 v10, v6
    v_mov_b32 v11, v7
    s_nop 1
    v_permlane32_swap_b32 v4, v8
    v_permlane32_swap_b32 v5, v9
    v_permlane32_swap_b32 v6, v10
    v_permlane32_swap_b32 v7, v11
    s_nop 1
    v_add_f32 v5, v5, v9
    v_add_f32 v7, v7, v11
    v_sub_f32 v9, v4, v8
    v_sub_f32 v11, v6, v10
    v_add_f32 v4, v4, v8
    v_add_f32 v6, v6, v10
    v_mul_f32 v8, 0x38800000, v9
    v_mul_f32 v10, 0x38800000, v11
    v_fmac_f32 v5, v8, v9
    v_fmac_f32 v7, v10, v11
    v_cndmask_b32 v6, v4, v6, vcc
    v_cndmask_b32 v7, v5, v7, vcc
    s_branch L_mg2
L_alone3:
    s_waitcnt lgkmcnt(0)
    v_xor_b32 v36, 0x2000, v13
    v_add_u32 v37, 0x40000, v36
    v_mov_b32 v4, 0
    v_mov_b32 v5, 0
    v_mov_b32 v6, 0
    v_mov_b32 v7, 0
L_so3:
    global_load_dwordx4 v[16:19], v36, s[8:9] offset:-4096
    global_load_dwordx4 v[20:23], v37, s[8:9] offset:-4096
    s_add_u32 s46, s46, 1
    s_and_b32 s5, s46, 7
    s_cselect_b32 s5, 0, 0x2000
    s_add_u32 s5, s5, 0x400
    s_waitcnt vmcnt(0)
    v_add_u32 v36, s5, v36
    v_add_u32 v37, s5, v37
    v_dot2c_f32_bf16 v4, s30, v16
    v_dot2c_f32_bf16 v5, v16, v16
    v_dot2c_f32_bf16 v6, s30, v20
    v_dot2c_f32_bf16 v7, v20, v20
    v_dot2c_f32_bf16 v4, s30, v17
    v_dot2c_f32_bf16 v5, v17, v17
    v_dot2c_f32_bf16 v6, s30, v21
    v_dot2c_f32_bf16 v7, v21, v21
    v_dot2c_f32_bf16 v4, s30, v18
    v_dot2c_f32_bf16 v5, v18, v18
    v_dot2c_f32_bf16 v6, s30, v22
    v_dot2c_f32_bf16 v7, v22, v22
    v_dot2c_f32_bf16 v4, s30, v19
    v_dot2c_f32_bf16 v5, v19, v19
    v_dot2c_f32_bf16 v6, s30, v23
    v_dot2c_f32_bf16 v7, v23, v23
    s_cmp_lt_u32 s46, 32
    s_cbranch_scc1 L_so3
    s_nop 1
    v_mul_f32 v10, 0xbb800000, v4
    v_mul_f32 v11, 0xbb800000, v6
    v_fmac_f32 v5, v10, v4
    v_fmac_f32 v7, v11, v6
    s_nop 0
    v_add_f32_dpp v8, v4, v4 quad_perm:[1,0,3,2] row_mask:0xf bank_mask:0xf
    v_add_f32_dpp v9, v6, v6 quad_perm:[1,0,3,2] row_mask:0xf bank_mask:0xf
    s_nop 0
    v_add_f32_dpp v8, v8, v8 quad_perm:[2,3,0,1] row_mask:0xf bank_mask:0xf
    v_add_f32_dpp v9, v9, v9 quad_perm:[2,3,0,1] row_mask:0xf bank_mask:0xf
    s_nop 0
    v_add_f32_dpp v8, v8, v8 row_half_mirror row_mask:0xf bank_mask:0xf
    v_add_f32_dpp v9, v9, v9 row_half_mirror row_mask:0xf bank_mask:0xf
    s_nop 0
    v_add_f32_dpp v8, v8, v8 row_mirror row_mask:0xf bank_mask:0xf
    v_add_f32_dpp v9, v9, v9 row_mirror row_mask:0xf bank_mask:0xf
    v_fmac_f32 v4, 0xbd800000, v8
    v_fmac_f32 v6, 0xbd800000, v9
    v_mul_f32 v10, 0x3b800000, v4
    v_mul_f32 v11, 0x3b800000, v6
    v_fmac_f32 v5, v10, v4
    v_fmac_f32 v7, v11, v6
    v_mov_b32 v4, v8
    v_mov_b32 v6, v9
    v_add_f32_dpp v5, v5, v5 quad_perm:[1,0,3,2] row_mask:0xf bank_mask:0xf
    v_add_f32_dpp v7, v7, v7 quad_perm:[1,0,3,2] row_mask:0xf bank_mask:0xf
    s_nop 0
    v_add_f32_dpp v5, v5, v5 quad_perm:[2,3,0,1] row_mask:0xf bank_mask:0xf
    v_add_f32_dpp v7, v7, v7 quad_perm:[2,3,0,1] row_mask:0xf bank_mask:0xf
    s_nop 0
    v_add_f32_dpp v5, v5, v5 row_half_mirror row_mask:0xf bank_mask:0xf
    v_add_f32_dpp v7, v7, v7 row_half_mirror row_mask:0xf bank_mask:0xf
    s_nop 0
    v_add_f32_dpp v5, v5, v5 row_mirror row_mask:0xf bank_mask:0xf
    v_add_f32_dpp v7, v7, v7 row_mirror row_mask:0xf bank_mask:0xf
    v_mov_b32 v8, v4
    v_mov_b32 v9, v5
    v_mov_b32 v10, v6
    v_mov_b32 v11, v7
    s_nop 1
    v_permlane16_swap_b32 v4, v8
    v_permlane16_swap_b32 v5, v9
    v_permlane16_swap_b32 v6, v10
    v_permlane16_swap_b32 v7, v11
    s_nop 1
    v_add_f32 v5, v5, v9
    v_add_f32 v7, v7, v11
    v_sub_f32 v9, v4, v8
    v_sub_f32 v11, v6, v10
    v_add_f32 v4, v4, v8
    v_add_f32 v6, v6, v10
    v_mul_f32 v8, 0x39000000, v9
    v_mul_f32 v10, 0x39000000, v11
    v_fmac_f32 v5, v8, v9
    v_fmac_f32 v7, v10, v11
    v_mov_b32 v8, v4
    v_mov_b32 v9, v5
    v_mov_b32 v10, v6
    v_mov_b32 v11, v7
    s_nop 1
    v_permlane32_swap_b32 v4, v8
    v_permlane32_swap_b32 v5, v9
    v_permlane32_swap_b32 v6, v10
    v_permlane32_swap_b32 v7, v11
    s_nop 1
    v_add_f32 v5, v5, v9
    v_add_f32 v7, v7, v11
    v_sub_f32 v9, v4, v8
    v_sub_f32 v11, v6, v10
    v_add_f32 v4, v4, v8
    v_add_f32 v6, v6, v10
    v_mul_f32 v8, 0x38800000, v9
    v_mul_f32 v10, 0x38800000, v11
    v_fmac_f32 v5, v8, v9
    v_fmac_f32 v7, v10, v11
    v_cndmask_b32 v6, v4, v6, vcc
    v_cndmask_b32 v7, v5, v7, vcc
    s_branch L_mg3
L_dpoll:
    s_lshr_b32 s5, s2, 2
    s_or_b32 s5, s5, s3
    s_cselect_b32 s46, 200, 1
    v_mov_b32 v4, s36
    s_mov_b64 exec, 1
L_dp:
    global_load_dword v8, v4, s[16:17] sc1
    s_waitcnt vmcnt(0)
    v_readfirstlane_b32 s38, v8
    s_cmp_lg_u32 s38, 0
    s_cbranch_scc1 L_dq
    s_sleep 2
    s_sub_u32 s46, s46, 1
    s_cmp_lg_u32 s46, 0
    s_cbranch_scc1 L_dp
    v_mov_b32 v6, 2
    v_mov_b32 v7, 0
    global_atomic_cmpswap v8, v4, v[6:7], s[16:17] sc0 sc1
    s_waitcnt vmcnt(0)
    v_readfirstlane_b32 s38, v8
L_dq:
    s_mov_b64 exec, -1
    s_branch L_dgot
    .p2align 7
L_odd:
    s_cmp_lg_u32 s3, 0
    s_cbranch_scc1 L_pf
    s_bitcmp1_b32 s2, 2
    s_cbranch_scc1 L_go
    s_and_b32 s36, s2, 3
    s_lshl_b32 s36, s36, 6
    s_and_b32 s5, s2, 31
    s_lshl_b32 s5, s5, 7
    s_sub_u32 s34, s44, s5
    s_bfe_u32 s56, s2, 0x10003
    s_lshl_b32 s5, s56, 13
    s_add_u32 s34, s34, s5
    s_add_u32 s34, s34, 0x1000000
    s_xor_b32 s35, s34, 0x2000
    s_bfe_u32 s5, s2, 0x10005
    s_xor_b32 s56, s56, s5
    s_or_b32 s56, s56, 2
    s_mov_b32 s57, 0
    s_mov_b64 s[54:55], -1
    .fill ((0x1c - (. - standalone__groupnorm__sampling_kernel)) & 0x1f) / 4, 4, 0xbf800000
    s_waitcnt lgkmcnt(0)
    s_load_dword s53, s[8:9], s34 glc
    s_load_dword s54, s[8:9], s35 glc
    s_waitcnt lgkmcnt(1)
    s_nop 7
    s_cmp_lg_u32 s54, -1
    s_cbranch_scc1 L_go2
    s_waitcnt lgkmcnt(0)
    s_load_dword s53, s[8:9], s34 glc
    s_load_dword s55, s[8:9], s35 glc
    s_waitcnt lgkmcnt(1)
    s_nop 7
    s_cmp_lg_u32 s55, -1
    s_cbranch_scc1 L_go2
    s_atomic_cmpswap s[56:57], s[16:17], s36
    s_branch L_go2
L_pf:
    s_cmp_ge_u32 s2, 8
    s_cbranch_scc1 L_go
    s_getpc_b64 s[34:35]
L_pc:
    s_sub_u32 s34, s34, L_pc - standalone__groupnorm__sampling_kernel
    s_subb_u32 s35, s35, 0
    v_lshlrev_b32 v4, 3, v12
    .if ((L_hot_end - standalone__groupnorm__sampling_kernel + 127) >> 7) > 64
    global_load_dword v15, v4, s[34:35]
    v_add_u32 v4, 0x2000, v4
    .endif
    .if ((L_hot_end - standalone__groupnorm__sampling_kernel + 127) >> 7) != 64
    s_bfm_b64 exec, ((L_hot_end - standalone__groupnorm__sampling_kernel + 127) >> 7) & 63, 0
    .endif
    global_load_dword v15, v4, s[34:35]
    s_mov_b64 exec, -1
    s_branch L_go
.section .rodata,"a"
.p2align 6
.amdhsa_kernel standalone__groupnorm__sampling_kernel
  .amdhsa_next_free_vgpr 172
  .amdhsa_next_free_sgpr 76
  .amdhsa_accum_offset 172
  .amdhsa_group_segment_fixed_size 0
  .amdhsa_kernarg_size 48
  .amdhsa_user_sgpr_count 2
  .amdhsa_user_sgpr_kernarg_segment_ptr 1
  .amdhsa_system_sgpr_workgroup_id_x 1
  .amdhsa_float_denorm_mode_32 3
.end_amdhsa_kernel
```
